```python
import torch

def _softmax(x, axis=-1):
    return torch.softmax(x, dim=axis)
def _gelu(x):
    return torch.nn.functional.gelu(x, approximate="tanh")
def _silu(x):
    return torch.nn.functional.silu(x)
def _sigmoid(x):
    return torch.sigmoid(x)
def _layernorm(x, axis=-1, eps=1e-5):
    m = x.mean(dim=axis, keepdim=True)
    v = x.var(dim=axis, keepdim=True, unbiased=False)
    return (x - m) / torch.sqrt(v + eps)
def _scatter_add(tgt, idx, src, axis=0):
    return tgt.clone().index_add_(axis, idx, src)
def _segment_sum(src, seg, n):
    out = torch.zeros((n,) + src.shape[1:], dtype=src.dtype)
    return out.index_add_(0, seg, src)
def _pad(x, pw):
    flat = tuple(v for pair in reversed(pw) for v in pair)
    return torch.nn.functional.pad(x, flat)

kernel_name = 'gated_mix__gqa_block_cached__swiglu_ffn__decode'

def setup_inputs():

    _w = (lambda a: (lambda t: t.to(torch.bfloat16) if t.is_floating_point() else t)(torch.as_tensor(a)))
    def _A_setup():
        B, Sq, D = 2, 1, 512
        Hq, Hkv, Sk, Dh = 32, 8, 8192, 128
        assert Hq % Hkv == 0, (Hq, Hkv)
        return {
            "x": _w((lambda *s: torch.randn(*s, dtype=torch.bfloat16) * 0.05)(B, Sq, D)),
            "k_cache": _w((lambda *s: torch.randn(*s, dtype=torch.bfloat16) * 6.4)(B, Hkv, Sk, Dh)),
            "v_cache": _w((lambda *s: torch.randn(*s, dtype=torch.bfloat16) * 0.2)(B, Hkv, Sk, Dh)),
            "wq": _w((lambda *s: torch.randn(*s, dtype=torch.bfloat16) * 6.4)(D, Hq * Dh) * (D ** -0.5)),
            "wo": _w((lambda *s: torch.randn(*s, dtype=torch.bfloat16) * 0.2)(Hq * Dh, D) * ((Hq * Dh) ** -0.5)),
        }
    _A_in = _A_setup()

    def _B_setup():
        B, S, D, F = 2, 1, 512, 1792
        return {
            "x": _w((lambda *s: torch.randn(*s, dtype=torch.bfloat16) * 0.05)(B, S, D)),
            "w_gate": _w((lambda *s: torch.randn(*s, dtype=torch.bfloat16) * 0.05)(D, F)),
            "w_up": _w((lambda *s: torch.randn(*s, dtype=torch.bfloat16) * 0.05)(D, F)),
            "w_down": _w((lambda *s: torch.randn(*s, dtype=torch.bfloat16) * 0.05)(F, D)),
        }
    _B_in = _B_setup()

    return {
        "A_x": _A_in["x"],
        "A_k_cache": _A_in["k_cache"],
        "A_v_cache": _A_in["v_cache"],
        "A_wq": _A_in["wq"],
        "A_wo": _A_in["wo"],
        "B_x": _B_in["x"],
        "B_w_gate": _B_in["w_gate"],
        "B_w_up": _B_in["w_up"],
        "B_w_down": _B_in["w_down"],
        "gate_w": _w((lambda *s: torch.randn(*s, dtype=torch.bfloat16) * 0.05)(512) * 16.0),
    }

def reference(A_x, A_k_cache, A_v_cache, A_wq, A_wo, B_x, B_w_gate, B_w_up, B_w_down, gate_w):
    def _A_ref(x, k_cache, v_cache, wq, wo):
        B, Sq, D = x.shape
        Hq, Dh = 32, 128
        Hkv = k_cache.shape[1]
        rep = Hq // Hkv
        q = (lambda x, *d: x.permute(*d))((x @ wq).reshape(B, Sq, Hq, Dh), 0, 2, 1, 3)
        k = (lambda x, n, axis: torch.repeat_interleave(x, n, dim=axis))(k_cache, rep, axis=1)
        v = (lambda x, n, axis: torch.repeat_interleave(x, n, dim=axis))(v_cache, rep, axis=1)
        scores = torch.einsum("bhqd,bhkd->bhqk", q, k) * (Dh ** -0.5)
        p = _softmax(scores, axis=-1)
        o = torch.einsum("bhqk,bhkd->bhqd", p, v)
        return (lambda x, *d: x.permute(*d))(o, 0, 2, 1, 3).reshape(B, Sq, Hq * Dh) @ wo

    def _B_ref(x, w_gate, w_up, w_down):
        g = _silu(x @ w_gate)
        u = x @ w_up
        return (g * u) @ w_down

    x = A_x
    g = _sigmoid((x * gate_w).sum(-1, keepdims=True))
    a = _A_ref(x, A_k_cache, A_v_cache, A_wq, A_wo)
    b = _B_ref(x, B_w_gate, B_w_up, B_w_down)
    return g * a + (1 - g) * b
```

```asm
; @launch grid=(256,1,1) block=(384,1,1) lds=163840
.amdgcn_target "amdgcn-amd-amdhsa--gfx950"
.text
.globl gated_mix__gqa_block_cached__swiglu_ffn__decode_kernel
.p2align 8
.type gated_mix__gqa_block_cached__swiglu_ffn__decode_kernel,@function
gated_mix__gqa_block_cached__swiglu_ffn__decode_kernel:
    s_cmp_ge_u32 s2, 256
    s_cbranch_scc1 L_end
    s_load_dwordx16 s[4:19], s[0:1], 0
    s_load_dwordx8 s[20:27], s[0:1], 64
    s_load_dwordx2 s[28:29], s[0:1], 96
    v_lshrrev_b32 v4, 6, v0
    v_and_b32 v1, 63, v0
    v_readfirstlane_b32 s3, v4
    v_and_b32 v2, 15, v1
    v_lshrrev_b32 v3, 4, v1
    v_mov_b32 v8, 157248
    s_and_b32 s34, s2, 7
    s_lshr_b32 s35, s2, 3
    s_mov_b32 s33, 1023
    s_lshr_b32 s42, s35, 4
    s_lshl_b32 s42, s42, 3
    s_add_u32 s42, s42, s34
    s_lshl_b32 s42, s42, 21
    s_and_b32 s43, s35, 15
    s_lshl_b32 s43, s43, 17
    s_add_u32 s45, s42, s43
    s_cmp_eq_u32 s3, 4
    s_cbranch_scc1 L_helper
    s_cmp_eq_u32 s3, 5
    s_cbranch_scc1 L_loader
    s_lshl_b32 s42, s3, 10
    v_lshlrev_b32 v4, 4, v1
    v_add_u32 v13, s42, v4
    s_mul_i32 s36, s3, 36864
    s_waitcnt lgkmcnt(0)
    s_load_dword s30, s[28:29], 0
    s_add_u32 s56, s6, s45
    s_addc_u32 s57, s7, 0
    s_mov_b32 s58, 131072
    s_mov_b32 s59, 0x20000
    buffer_load_dwordx4 v[116:119], v13, s[56:59], 0 offen nt
    s_mov_b32 s37, 4096
    buffer_load_dwordx4 v[120:123], v13, s[56:59], s37 offen nt
    s_mov_b32 s37, 8192
    buffer_load_dwordx4 v[124:127], v13, s[56:59], s37 offen nt
    s_mov_b32 s37, 12288
    buffer_load_dwordx4 v[128:131], v13, s[56:59], s37 offen nt
    s_mov_b32 s37, 16384
    buffer_load_dwordx4 v[132:135], v13, s[56:59], s37 offen nt
    s_mov_b32 s37, 20480
    buffer_load_dwordx4 v[136:139], v13, s[56:59], s37 offen nt
    s_mov_b32 s37, 24576
    buffer_load_dwordx4 v[140:143], v13, s[56:59], s37 offen nt
    s_mov_b32 s37, 28672
    buffer_load_dwordx4 v[144:147], v13, s[56:59], s37 offen nt
    s_lshr_b32 s42, s35, 4
    s_lshl_b32 s43, s34, 1
    s_add_u32 s43, s43, s42
    s_lshl_b32 s43, s43, 4
    s_and_b32 s44, s35, 15
    s_add_u32 s47, s43, s44
    s_lshr_b32 s42, s35, 1
    s_lshl_b32 s48, s34, 4
    s_add_u32 s48, s48, s42
    s_and_b32 s49, s35, 1
    s_mul_i32 s50, s48, 14
    s_and_b32 s50, s50, -4
    s_mov_b32 s68, s28
    s_mov_b32 s69, s29
    s_mov_b32 s70, 1572864
    s_mov_b32 s71, 0x20000
    s_add_u32 s42, s36, 32768
    v_lshlrev_b32 v4, 8, v3
    v_xor_b32 v5, v3, v2
    v_lshlrev_b32 v5, 4, v5
    v_add_u32 v6, v4, v5
    v_add_u32 v14, s42, v6
    v_xor_b32 v15, 64, v14
    v_xor_b32 v16, 128, v14
    v_xor_b32 v17, 192, v14
    v_lshl_add_u32 v5, v2, 8, v5
    v_add_u32 v18, s42, v5
    v_xor_b32 v19, 64, v18
    v_xor_b32 v20, 128, v18
    v_xor_b32 v21, 192, v18
    v_lshrrev_b32 v4, 2, v1
    v_and_b32 v5, 7, v4
    v_lshlrev_b32 v5, 5, v5
    v_lshl_add_u32 v5, v4, 8, v5
    v_and_b32 v6, 3, v1
    v_lshl_add_u32 v5, v6, 3, v5
    v_add_u32 v22, s36, v5
    v_xor_b32 v23, 32, v22
    v_xor_b32 v24, 64, v22
    v_xor_b32 v25, 96, v22
    v_xor_b32 v26, 128, v22
    v_xor_b32 v27, 160, v22
    v_xor_b32 v28, 192, v22
    v_xor_b32 v29, 224, v22
    v_and_b32 v5, 3, v4
    v_lshl_add_u32 v9, v3, 3, v5
    v_lshrrev_b32 v5, 1, v5
    v_and_b32 v10, 1, v3
    v_lshl_add_u32 v5, v10, 1, v5
    v_lshlrev_b32 v5, 5, v5
    v_lshl_add_u32 v5, v9, 7, v5
    v_lshl_add_u32 v5, v6, 3, v5
    v_add_u32 v30, s36, v5
    v_xor_b32 v31, 32, v30
    v_xor_b32 v32, 64, v30
    v_xor_b32 v33, 96, v30
    s_lshl_b32 s42, s48, 15
    s_lshl_b32 s43, s49, 9
    s_add_u32 s42, s42, s43
    s_waitcnt lgkmcnt(0)
    s_add_u32 s31, s30, 1
    s_not_b32 s32, s31
    s_and_b32 s42, s31, s33
    v_mov_b32 v7, s42
    s_barrier
    s_lshl_b32 s42, s3, 2
    v_add_u32 v9, s42, v8
    s_waitcnt vmcnt(4)
    s_mov_b32 s37, 32768
    buffer_load_dwordx4 v[148:151], v13, s[56:59], s37 offen nt
    s_mov_b32 s37, 36864
    buffer_load_dwordx4 v[152:155], v13, s[56:59], s37 offen nt
    s_mov_b32 s37, 40960
    buffer_load_dwordx4 v[156:159], v13, s[56:59], s37 offen nt
    s_mov_b32 s37, 45056
    buffer_load_dwordx4 v[160:163], v13, s[56:59], s37 offen nt
    ds_write_b128 v14, v[116:119] offset:0
    ds_write_b128 v15, v[120:123] offset:1024
    ds_write_b128 v16, v[124:127] offset:2048
    ds_write_b128 v17, v[128:131] offset:3072
    ds_read_b128 v[116:119], v18
    ds_read_b128 v[120:123], v19
    ds_read_b128 v[124:127], v20
    ds_read_b128 v[128:131], v21
    s_waitcnt vmcnt(4)
    s_mov_b32 s37, 49152
    buffer_load_dwordx4 v[164:167], v13, s[56:59], s37 offen nt
    s_mov_b32 s37, 53248
    buffer_load_dwordx4 v[168:171], v13, s[56:59], s37 offen nt
    s_mov_b32 s37, 57344
    buffer_load_dwordx4 v[172:175], v13, s[56:59], s37 offen nt
    s_mov_b32 s37, 61440
    buffer_load_dwordx4 v[176:179], v13, s[56:59], s37 offen nt
    s_waitcnt lgkmcnt(0)
    ds_write_b128 v14, v[132:135] offset:0
    ds_write_b128 v15, v[136:139] offset:1024
    ds_write_b128 v16, v[140:143] offset:2048
    ds_write_b128 v17, v[144:147] offset:3072
    ds_read_b128 v[132:135], v18
    ds_read_b128 v[136:139], v19
    ds_read_b128 v[140:143], v20
    ds_read_b128 v[144:147], v21
    s_waitcnt vmcnt(4)
    s_mov_b32 s37, 65536
    buffer_load_dwordx4 v[180:183], v13, s[56:59], s37 offen nt
    s_mov_b32 s37, 69632
    buffer_load_dwordx4 v[184:187], v13, s[56:59], s37 offen nt
    s_mov_b32 s37, 73728
    buffer_load_dwordx4 v[188:191], v13, s[56:59], s37 offen nt
    s_mov_b32 s37, 77824
    buffer_load_dwordx4 v[192:195], v13, s[56:59], s37 offen nt
    s_waitcnt lgkmcnt(0)
    ds_write_b128 v14, v[148:151] offset:0
    ds_write_b128 v15, v[152:155] offset:1024
    ds_write_b128 v16, v[156:159] offset:2048
    ds_write_b128 v17, v[160:163] offset:3072
    ds_read_b128 v[148:151], v18
    ds_read_b128 v[152:155], v19
    ds_read_b128 v[156:159], v20
    ds_read_b128 v[160:163], v21
    s_waitcnt vmcnt(4)
    s_mov_b32 s37, 81920
    buffer_load_dwordx4 v[196:199], v13, s[56:59], s37 offen nt
    s_mov_b32 s37, 86016
    buffer_load_dwordx4 v[200:203], v13, s[56:59], s37 offen nt
    s_mov_b32 s37, 90112
    buffer_load_dwordx4 v[204:207], v13, s[56:59], s37 offen nt
    s_mov_b32 s37, 94208
    buffer_load_dwordx4 v[208:211], v13, s[56:59], s37 offen nt
    s_waitcnt lgkmcnt(0)
    ds_write_b128 v14, v[164:167] offset:0
    ds_write_b128 v15, v[168:171] offset:1024
    ds_write_b128 v16, v[172:175] offset:2048
    ds_write_b128 v17, v[176:179] offset:3072
    ds_read_b128 v[164:167], v18
    ds_read_b128 v[168:171], v19
    ds_read_b128 v[172:175], v20
    ds_read_b128 v[176:179], v21
    s_waitcnt vmcnt(4)
    s_mov_b32 s37, 98304
    buffer_load_dwordx4 v[212:215], v13, s[56:59], s37 offen nt
    s_mov_b32 s37, 102400
    buffer_load_dwordx4 v[216:219], v13, s[56:59], s37 offen nt
    s_mov_b32 s37, 106496
    buffer_load_dwordx4 v[220:223], v13, s[56:59], s37 offen nt
    s_mov_b32 s37, 110592
    buffer_load_dwordx4 v[224:227], v13, s[56:59], s37 offen nt
    s_waitcnt lgkmcnt(0)
    ds_write_b128 v14, v[180:183] offset:0
    ds_write_b128 v15, v[184:187] offset:1024
    ds_write_b128 v16, v[188:191] offset:2048
    ds_write_b128 v17, v[192:195] offset:3072
    ds_read_b128 v[180:183], v18
    ds_read_b128 v[184:187], v19
    ds_read_b128 v[188:191], v20
    ds_read_b128 v[192:195], v21
    s_waitcnt vmcnt(4)
    s_mov_b32 s37, 114688
    buffer_load_dwordx4 v[228:231], v13, s[56:59], s37 offen nt
    s_mov_b32 s37, 118784
    buffer_load_dwordx4 v[232:235], v13, s[56:59], s37 offen nt
    s_mov_b32 s37, 122880
    buffer_load_dwordx4 v[236:239], v13, s[56:59], s37 offen nt
    s_mov_b32 s37, 126976
    buffer_load_dwordx4 v[240:243], v13, s[56:59], s37 offen nt
    v_mov_b32 v4, 1
    ds_write_b32 v9, v4 offset:0
    s_waitcnt lgkmcnt(1)
    ds_write_b128 v14, v[196:199] offset:0
    ds_write_b128 v15, v[200:203] offset:1024
    ds_write_b128 v16, v[204:207] offset:2048
    ds_write_b128 v17, v[208:211] offset:3072
    ds_read_b128 v[196:199], v18
    ds_read_b128 v[200:203], v19
    ds_read_b128 v[204:207], v20
    ds_read_b128 v[208:211], v21
    s_waitcnt vmcnt(4)
    v_mov_b32 v4, 2
    ds_write_b32 v9, v4 offset:0
    s_waitcnt lgkmcnt(1)
    ds_write_b128 v14, v[212:215] offset:0
    ds_write_b128 v15, v[216:219] offset:1024
    ds_write_b128 v16, v[220:223] offset:2048
    ds_write_b128 v17, v[224:227] offset:3072
    ds_read_b128 v[212:215], v18
    ds_read_b128 v[216:219], v19
    ds_read_b128 v[220:223], v20
    ds_read_b128 v[224:227], v21
    s_waitcnt vmcnt(0)
    v_mov_b32 v4, 3
    ds_write_b32 v9, v4 offset:0
    s_waitcnt lgkmcnt(1)
    ds_write_b128 v14, v[228:231] offset:0
    ds_write_b128 v15, v[232:235] offset:1024
    ds_write_b128 v16, v[236:239] offset:2048
    ds_write_b128 v17, v[240:243] offset:3072
    ds_read_b128 v[228:231], v18
    ds_read_b128 v[232:235], v19
    ds_read_b128 v[236:239], v20
    ds_read_b128 v[240:243], v21
    s_waitcnt lgkmcnt(0)
    v_mov_b32 v4, 4
    ds_write_b32 v9, v4 offset:0
    s_mov_b32 s46, 1048576
L_fw1:
    ds_read_b32 v36, v8 offset:20
    s_waitcnt lgkmcnt(0)
    v_cmp_gt_u32 vcc, 1, v36
    s_cbranch_vccz L_fd2
    s_sleep 1
    s_sub_u32 s46, s46, 1
    s_cmp_lg_u32 s46, 0
    s_cbranch_scc1 L_fw1
L_fd2:
    v_and_b32 v4, 3, v2
    v_lshlrev_b32 v4, 8, v4
    v_lshl_add_u32 v4, v3, 4, v4
    v_add_u32 v9, 155648, v4
    ds_read_b128 v[100:103], v9 offset:0
    ds_read_b128 v[104:107], v9 offset:64
    ds_read_b128 v[108:111], v9 offset:128
    ds_read_b128 v[112:115], v9 offset:192
    s_waitcnt lgkmcnt(0)
    v_mfma_f32_16x16x32_bf16 v[68:71], v[116:119], v[100:103], 0
    v_mfma_f32_16x16x32_bf16 v[72:75], v[132:135], v[100:103], 0
    v_mfma_f32_16x16x32_bf16 v[76:79], v[148:151], v[100:103], 0
    v_mfma_f32_16x16x32_bf16 v[80:83], v[164:167], v[100:103], 0
    v_mfma_f32_16x16x32_bf16 v[84:87], v[180:183], v[100:103], 0
    v_mfma_f32_16x16x32_bf16 v[88:91], v[196:199], v[100:103], 0
    v_mfma_f32_16x16x32_bf16 v[92:95], v[212:215], v[100:103], 0
    v_mfma_f32_16x16x32_bf16 v[96:99], v[228:231], v[100:103], 0
    v_mfma_f32_16x16x32_bf16 v[68:71], v[120:123], v[104:107], v[68:71]
    v_mfma_f32_16x16x32_bf16 v[72:75], v[136:139], v[104:107], v[72:75]
    v_mfma_f32_16x16x32_bf16 v[76:79], v[152:155], v[104:107], v[76:79]
    v_mfma_f32_16x16x32_bf16 v[80:83], v[168:171], v[104:107], v[80:83]
    v_mfma_f32_16x16x32_bf16 v[84:87], v[184:187], v[104:107], v[84:87]
    v_mfma_f32_16x16x32_bf16 v[88:91], v[200:203], v[104:107], v[88:91]
    v_mfma_f32_16x16x32_bf16 v[92:95], v[216:219], v[104:107], v[92:95]
    v_mfma_f32_16x16x32_bf16 v[96:99], v[232:235], v[104:107], v[96:99]
    v_mfma_f32_16x16x32_bf16 v[68:71], v[124:127], v[108:111], v[68:71]
    v_mfma_f32_16x16x32_bf16 v[72:75], v[140:143], v[108:111], v[72:75]
    v_mfma_f32_16x16x32_bf16 v[76:79], v[156:159], v[108:111], v[76:79]
    v_mfma_f32_16x16x32_bf16 v[80:83], v[172:175], v[108:111], v[80:83]
    v_mfma_f32_16x16x32_bf16 v[84:87], v[188:191], v[108:111], v[84:87]
    v_mfma_f32_16x16x32_bf16 v[88:91], v[204:207], v[108:111], v[88:91]
    v_mfma_f32_16x16x32_bf16 v[92:95], v[220:223], v[108:111], v[92:95]
    v_mfma_f32_16x16x32_bf16 v[96:99], v[236:239], v[108:111], v[96:99]
    v_mfma_f32_16x16x32_bf16 v[68:71], v[128:131], v[112:115], v[68:71]
    v_mfma_f32_16x16x32_bf16 v[72:75], v[144:147], v[112:115], v[72:75]
    v_mfma_f32_16x16x32_bf16 v[76:79], v[160:163], v[112:115], v[76:79]
    v_mfma_f32_16x16x32_bf16 v[80:83], v[176:179], v[112:115], v[80:83]
    v_mfma_f32_16x16x32_bf16 v[84:87], v[192:195], v[112:115], v[84:87]
    v_mfma_f32_16x16x32_bf16 v[88:91], v[208:211], v[112:115], v[88:91]
    v_mfma_f32_16x16x32_bf16 v[92:95], v[224:227], v[112:115], v[92:95]
    v_mfma_f32_16x16x32_bf16 v[96:99], v[240:243], v[112:115], v[96:99]
    s_mov_b32 s42, 0x3db504f3
    v_cvt_pk_bf16_f32 v4, v68, v69
    v_lshlrev_b32 v68, 16, v4
    v_and_b32 v69, 0xffff0000, v4
    v_mul_f32 v68, s42, v68
    v_mul_f32 v69, s42, v69
    v_cvt_pk_bf16_f32 v4, v68, v69
    v_lshlrev_b32 v68, 16, v4
    v_and_b32 v69, 0xffff0000, v4
    v_cvt_pk_bf16_f32 v4, v70, v71
    v_lshlrev_b32 v70, 16, v4
    v_and_b32 v71, 0xffff0000, v4
    v_mul_f32 v70, s42, v70
    v_mul_f32 v71, s42, v71
    v_cvt_pk_bf16_f32 v4, v70, v71
    v_lshlrev_b32 v70, 16, v4
    v_and_b32 v71, 0xffff0000, v4
    v_cvt_pk_bf16_f32 v4, v72, v73
    v_lshlrev_b32 v72, 16, v4
    v_and_b32 v73, 0xffff0000, v4
    v_mul_f32 v72, s42, v72
    v_mul_f32 v73, s42, v73
    v_cvt_pk_bf16_f32 v4, v72, v73
    v_lshlrev_b32 v72, 16, v4
    v_and_b32 v73, 0xffff0000, v4
    v_cvt_pk_bf16_f32 v4, v74, v75
    v_lshlrev_b32 v74, 16, v4
    v_and_b32 v75, 0xffff0000, v4
    v_mul_f32 v74, s42, v74
    v_mul_f32 v75, s42, v75
    v_cvt_pk_bf16_f32 v4, v74, v75
    v_lshlrev_b32 v74, 16, v4
    v_and_b32 v75, 0xffff0000, v4
    v_cvt_pk_bf16_f32 v4, v76, v77
    v_lshlrev_b32 v76, 16, v4
    v_and_b32 v77, 0xffff0000, v4
    v_mul_f32 v76, s42, v76
    v_mul_f32 v77, s42, v77
    v_cvt_pk_bf16_f32 v4, v76, v77
    v_lshlrev_b32 v76, 16, v4
    v_and_b32 v77, 0xffff0000, v4
    v_cvt_pk_bf16_f32 v4, v78, v79
    v_lshlrev_b32 v78, 16, v4
    v_and_b32 v79, 0xffff0000, v4
    v_mul_f32 v78, s42, v78
    v_mul_f32 v79, s42, v79
    v_cvt_pk_bf16_f32 v4, v78, v79
    v_lshlrev_b32 v78, 16, v4
    v_and_b32 v79, 0xffff0000, v4
    v_cvt_pk_bf16_f32 v4, v80, v81
    v_lshlrev_b32 v80, 16, v4
    v_and_b32 v81, 0xffff0000, v4
    v_mul_f32 v80, s42, v80
    v_mul_f32 v81, s42, v81
    v_cvt_pk_bf16_f32 v4, v80, v81
    v_lshlrev_b32 v80, 16, v4
    v_and_b32 v81, 0xffff0000, v4
    v_cvt_pk_bf16_f32 v4, v82, v83
    v_lshlrev_b32 v82, 16, v4
    v_and_b32 v83, 0xffff0000, v4
    v_mul_f32 v82, s42, v82
    v_mul_f32 v83, s42, v83
    v_cvt_pk_bf16_f32 v4, v82, v83
    v_lshlrev_b32 v82, 16, v4
    v_and_b32 v83, 0xffff0000, v4
    v_cvt_pk_bf16_f32 v4, v84, v85
    v_lshlrev_b32 v84, 16, v4
    v_and_b32 v85, 0xffff0000, v4
    v_mul_f32 v84, s42, v84
    v_mul_f32 v85, s42, v85
    v_cvt_pk_bf16_f32 v4, v84, v85
    v_lshlrev_b32 v84, 16, v4
    v_and_b32 v85, 0xffff0000, v4
    v_cvt_pk_bf16_f32 v4, v86, v87
    v_lshlrev_b32 v86, 16, v4
    v_and_b32 v87, 0xffff0000, v4
    v_mul_f32 v86, s42, v86
    v_mul_f32 v87, s42, v87
    v_cvt_pk_bf16_f32 v4, v86, v87
    v_lshlrev_b32 v86, 16, v4
    v_and_b32 v87, 0xffff0000, v4
    v_cvt_pk_bf16_f32 v4, v88, v89
    v_lshlrev_b32 v88, 16, v4
    v_and_b32 v89, 0xffff0000, v4
    v_mul_f32 v88, s42, v88
    v_mul_f32 v89, s42, v89
    v_cvt_pk_bf16_f32 v4, v88, v89
    v_lshlrev_b32 v88, 16, v4
    v_and_b32 v89, 0xffff0000, v4
    v_cvt_pk_bf16_f32 v4, v90, v91
    v_lshlrev_b32 v90, 16, v4
    v_and_b32 v91, 0xffff0000, v4
    v_mul_f32 v90, s42, v90
    v_mul_f32 v91, s42, v91
    v_cvt_pk_bf16_f32 v4, v90, v91
    v_lshlrev_b32 v90, 16, v4
    v_and_b32 v91, 0xffff0000, v4
    v_cvt_pk_bf16_f32 v4, v92, v93
    v_lshlrev_b32 v92, 16, v4
    v_and_b32 v93, 0xffff0000, v4
    v_mul_f32 v92, s42, v92
    v_mul_f32 v93, s42, v93
    v_cvt_pk_bf16_f32 v4, v92, v93
    v_lshlrev_b32 v92, 16, v4
    v_and_b32 v93, 0xffff0000, v4
    v_cvt_pk_bf16_f32 v4, v94, v95
    v_lshlrev_b32 v94, 16, v4
    v_and_b32 v95, 0xffff0000, v4
    v_mul_f32 v94, s42, v94
    v_mul_f32 v95, s42, v95
    v_cvt_pk_bf16_f32 v4, v94, v95
    v_lshlrev_b32 v94, 16, v4
    v_and_b32 v95, 0xffff0000, v4
    v_cvt_pk_bf16_f32 v4, v96, v97
    v_lshlrev_b32 v96, 16, v4
    v_and_b32 v97, 0xffff0000, v4
    v_mul_f32 v96, s42, v96
    v_mul_f32 v97, s42, v97
    v_cvt_pk_bf16_f32 v4, v96, v97
    v_lshlrev_b32 v96, 16, v4
    v_and_b32 v97, 0xffff0000, v4
    v_cvt_pk_bf16_f32 v4, v98, v99
    v_lshlrev_b32 v98, 16, v4
    v_and_b32 v99, 0xffff0000, v4
    v_mul_f32 v98, s42, v98
    v_mul_f32 v99, s42, v99
    v_cvt_pk_bf16_f32 v4, v98, v99
    v_lshlrev_b32 v98, 16, v4
    v_and_b32 v99, 0xffff0000, v4
    v_max3_f32 v34, v68, v69, v70
    v_max3_f32 v34, v34, v71, v72
    v_max3_f32 v34, v34, v73, v74
    v_max3_f32 v34, v34, v75, v76
    v_max3_f32 v34, v34, v77, v78
    v_max3_f32 v34, v34, v79, v80
    v_max3_f32 v34, v34, v81, v82
    v_max3_f32 v34, v34, v83, v84
    v_max3_f32 v34, v34, v85, v86
    v_max3_f32 v34, v34, v87, v88
    v_max3_f32 v34, v34, v89, v90
    v_max3_f32 v34, v34, v91, v92
    v_max3_f32 v34, v34, v93, v94
    v_max3_f32 v34, v34, v95, v96
    v_max3_f32 v34, v34, v97, v98
    v_max_f32 v34, v34, v99
    s_lshl_b32 s42, s3, 4
    s_add_u32 s42, s42, 156672
    v_lshlrev_b32 v9, 6, v2
    v_lshl_add_u32 v9, v3, 2, v9
    v_add_u32 v9, s42, v9
    s_mov_b32 exec_lo, 0xf000f
    s_mov_b32 exec_hi, 0xf000f
    ds_write_b32 v9, v34
    s_mov_b64 exec, -1
    s_lshl_b32 s42, s3, 2
    v_add_u32 v9, s42, v8
    v_mov_b32 v4, 1
    ds_write_b32 v9, v4 offset:48
    v_and_b32 v4, 3, v2
    v_lshlrev_b32 v4, 6, v4
    v_add_u32 v9, 156672, v4
    s_mov_b32 s46, 1048576
L_fw3:
    ds_read_b128 v[36:39], v8 offset:48
    s_waitcnt lgkmcnt(0)
    v_min_u32 v36, v36, v37
    v_min3_u32 v36, v36, v38, v39
    v_cmp_gt_u32 vcc, 1, v36
    s_cbranch_vccz L_fd4
    s_sleep 1
    s_sub_u32 s46, s46, 1
    s_cmp_lg_u32 s46, 0
    s_cbranch_scc1 L_fw3
L_fd4:
    ds_read_b128 v[36:39], v9 offset:0
    ds_read_b128 v[40:43], v9 offset:16
    ds_read_b128 v[44:47], v9 offset:32
    ds_read_b128 v[48:51], v9 offset:48
    v_mov_b32 v192, 0x3f803f80
    v_mov_b32 v193, 0x3f803f80
    v_mov_b32 v194, 0x3f803f80
    v_mov_b32 v195, 0x3f803f80
    s_waitcnt lgkmcnt(0)
    v_max3_f32 v34, v36, v37, v38
    v_max3_f32 v34, v34, v39, v40
    v_max3_f32 v34, v34, v41, v42
    v_max3_f32 v34, v34, v43, v44
    v_max3_f32 v34, v34, v45, v46
    v_max3_f32 v34, v34, v47, v48
    v_max3_f32 v34, v34, v49, v50
    v_max_f32 v34, v34, v51
    s_mov_b32 s42, 0x3fb8aa3b
    v_mul_f32 v34, s42, v34
    v_sub_f32 v35, 0, v34
    v_fma_f32 v68, v68, s42, v35
    v_fma_f32 v69, v69, s42, v35
    v_fma_f32 v70, v70, s42, v35
    v_fma_f32 v71, v71, s42, v35
    v_fma_f32 v72, v72, s42, v35
    v_fma_f32 v73, v73, s42, v35
    v_fma_f32 v74, v74, s42, v35
    v_fma_f32 v75, v75, s42, v35
    v_fma_f32 v76, v76, s42, v35
    v_fma_f32 v77, v77, s42, v35
    v_fma_f32 v78, v78, s42, v35
    v_fma_f32 v79, v79, s42, v35
    v_fma_f32 v80, v80, s42, v35
    v_fma_f32 v81, v81, s42, v35
    v_fma_f32 v82, v82, s42, v35
    v_fma_f32 v83, v83, s42, v35
    v_fma_f32 v84, v84, s42, v35
    v_fma_f32 v85, v85, s42, v35
    v_fma_f32 v86, v86, s42, v35
    v_fma_f32 v87, v87, s42, v35
    v_fma_f32 v88, v88, s42, v35
    v_fma_f32 v89, v89, s42, v35
    v_fma_f32 v90, v90, s42, v35
    v_fma_f32 v91, v91, s42, v35
    v_fma_f32 v92, v92, s42, v35
    v_fma_f32 v93, v93, s42, v35
    v_fma_f32 v94, v94, s42, v35
    v_fma_f32 v95, v95, s42, v35
    v_fma_f32 v96, v96, s42, v35
    v_fma_f32 v97, v97, s42, v35
    v_fma_f32 v98, v98, s42, v35
    v_fma_f32 v99, v99, s42, v35
    v_exp_f32 v68, v68
    v_exp_f32 v69, v69
    v_exp_f32 v70, v70
    v_exp_f32 v71, v71
    v_exp_f32 v72, v72
    v_exp_f32 v73, v73
    v_exp_f32 v74, v74
    v_exp_f32 v75, v75
    v_exp_f32 v76, v76
    v_exp_f32 v77, v77
    v_exp_f32 v78, v78
    v_exp_f32 v79, v79
    v_exp_f32 v80, v80
    v_exp_f32 v81, v81
    v_exp_f32 v82, v82
    v_exp_f32 v83, v83
    v_exp_f32 v84, v84
    v_exp_f32 v85, v85
    v_exp_f32 v86, v86
    v_exp_f32 v87, v87
    v_exp_f32 v88, v88
    v_exp_f32 v89, v89
    v_exp_f32 v90, v90
    v_exp_f32 v91, v91
    v_exp_f32 v92, v92
    v_exp_f32 v93, v93
    v_exp_f32 v94, v94
    v_exp_f32 v95, v95
    v_exp_f32 v96, v96
    v_exp_f32 v97, v97
    v_exp_f32 v98, v98
    v_exp_f32 v99, v99
    v_cvt_pk_bf16_f32 v100, v68, v69
    v_cvt_pk_bf16_f32 v101, v70, v71
    v_cvt_pk_bf16_f32 v102, v72, v73
    v_cvt_pk_bf16_f32 v103, v74, v75
    v_cvt_pk_bf16_f32 v104, v76, v77
    v_cvt_pk_bf16_f32 v105, v78, v79
    v_cvt_pk_bf16_f32 v106, v80, v81
    v_cvt_pk_bf16_f32 v107, v82, v83
    v_cvt_pk_bf16_f32 v108, v84, v85
    v_cvt_pk_bf16_f32 v109, v86, v87
    v_cvt_pk_bf16_f32 v110, v88, v89
    v_cvt_pk_bf16_f32 v111, v90, v91
    v_cvt_pk_bf16_f32 v112, v92, v93
    v_cvt_pk_bf16_f32 v113, v94, v95
    v_cvt_pk_bf16_f32 v114, v96, v97
    v_cvt_pk_bf16_f32 v115, v98, v99
    s_mov_b32 s54, 0xf000f
    s_mov_b32 s55, 0xf000f
    v_cndmask_b32 v116, 0, v100, s[54:55]
    v_cndmask_b32 v117, 0, v101, s[54:55]
    v_cndmask_b32 v118, 0, v102, s[54:55]
    v_cndmask_b32 v119, 0, v103, s[54:55]
    v_cndmask_b32 v120, 0, v104, s[54:55]
    v_cndmask_b32 v121, 0, v105, s[54:55]
    v_cndmask_b32 v122, 0, v106, s[54:55]
    v_cndmask_b32 v123, 0, v107, s[54:55]
    v_cndmask_b32 v124, 0, v108, s[54:55]
    v_cndmask_b32 v125, 0, v109, s[54:55]
    v_cndmask_b32 v126, 0, v110, s[54:55]
    v_cndmask_b32 v127, 0, v111, s[54:55]
    v_cndmask_b32 v128, 0, v112, s[54:55]
    v_cndmask_b32 v129, 0, v113, s[54:55]
    v_cndmask_b32 v130, 0, v114, s[54:55]
    v_cndmask_b32 v131, 0, v115, s[54:55]
    s_mov_b32 s54, 0xf000f0
    s_mov_b32 s55, 0xf000f0
    v_cndmask_b32 v132, 0, v100, s[54:55]
    v_cndmask_b32 v133, 0, v101, s[54:55]
    v_cndmask_b32 v134, 0, v102, s[54:55]
    v_cndmask_b32 v135, 0, v103, s[54:55]
    v_cndmask_b32 v136, 0, v104, s[54:55]
    v_cndmask_b32 v137, 0, v105, s[54:55]
    v_cndmask_b32 v138, 0, v106, s[54:55]
    v_cndmask_b32 v139, 0, v107, s[54:55]
    v_cndmask_b32 v140, 0, v108, s[54:55]
    v_cndmask_b32 v141, 0, v109, s[54:55]
    v_cndmask_b32 v142, 0, v110, s[54:55]
    v_cndmask_b32 v143, 0, v111, s[54:55]
    v_cndmask_b32 v144, 0, v112, s[54:55]
    v_cndmask_b32 v145, 0, v113, s[54:55]
    v_cndmask_b32 v146, 0, v114, s[54:55]
    v_cndmask_b32 v147, 0, v115, s[54:55]
    s_mov_b32 s54, 0xf000f00
    s_mov_b32 s55, 0xf000f00
    v_cndmask_b32 v148, 0, v100, s[54:55]
    v_cndmask_b32 v149, 0, v101, s[54:55]
    v_cndmask_b32 v150, 0, v102, s[54:55]
    v_cndmask_b32 v151, 0, v103, s[54:55]
    v_cndmask_b32 v152, 0, v104, s[54:55]
    v_cndmask_b32 v153, 0, v105, s[54:55]
    v_cndmask_b32 v154, 0, v106, s[54:55]
    v_cndmask_b32 v155, 0, v107, s[54:55]
    v_cndmask_b32 v156, 0, v108, s[54:55]
    v_cndmask_b32 v157, 0, v109, s[54:55]
    v_cndmask_b32 v158, 0, v110, s[54:55]
    v_cndmask_b32 v159, 0, v111, s[54:55]
    v_cndmask_b32 v160, 0, v112, s[54:55]
    v_cndmask_b32 v161, 0, v113, s[54:55]
    v_cndmask_b32 v162, 0, v114, s[54:55]
    v_cndmask_b32 v163, 0, v115, s[54:55]
    s_mov_b32 s54, 0xf000f000
    s_mov_b32 s55, 0xf000f000
    v_cndmask_b32 v164, 0, v100, s[54:55]
    v_cndmask_b32 v165, 0, v101, s[54:55]
    v_cndmask_b32 v166, 0, v102, s[54:55]
    v_cndmask_b32 v167, 0, v103, s[54:55]
    v_cndmask_b32 v168, 0, v104, s[54:55]
    v_cndmask_b32 v169, 0, v105, s[54:55]
    v_cndmask_b32 v170, 0, v106, s[54:55]
    v_cndmask_b32 v171, 0, v107, s[54:55]
    v_cndmask_b32 v172, 0, v108, s[54:55]
    v_cndmask_b32 v173, 0, v109, s[54:55]
    v_cndmask_b32 v174, 0, v110, s[54:55]
    v_cndmask_b32 v175, 0, v111, s[54:55]
    v_cndmask_b32 v176, 0, v112, s[54:55]
    v_cndmask_b32 v177, 0, v113, s[54:55]
    v_cndmask_b32 v178, 0, v114, s[54:55]
    v_cndmask_b32 v179, 0, v115, s[54:55]
    s_mov_b32 s46, 1048576
L_fw5:
    ds_read_b32 v36, v8 offset:32
    s_waitcnt lgkmcnt(0)
    v_cmp_gt_u32 vcc, 1, v36
    s_cbranch_vccz L_fd6
    s_sleep 1
    s_sub_u32 s46, s46, 1
    s_cmp_lg_u32 s46, 0
    s_cbranch_scc1 L_fw5
L_fd6:
    ds_read_b64_tr_b16 v[36:37], v22 offset:0
    ds_read_b64_tr_b16 v[38:39], v22 offset:4096
    ds_read_b64_tr_b16 v[40:41], v26 offset:0
    ds_read_b64_tr_b16 v[42:43], v26 offset:4096
    ds_read_b64_tr_b16 v[44:45], v23 offset:0
    ds_read_b64_tr_b16 v[46:47], v23 offset:4096
    ds_read_b64_tr_b16 v[48:49], v27 offset:0
    ds_read_b64_tr_b16 v[50:51], v27 offset:4096
    v_mfma_f32_16x16x32_bf16 v[188:191], v[192:195], v[116:119], 0
    s_waitcnt lgkmcnt(6)
    v_mfma_f32_16x16x32_bf16 v[180:183], v[36:39], v[116:119], 0
    ds_read_b64_tr_b16 v[52:53], v24 offset:0
    ds_read_b64_tr_b16 v[54:55], v24 offset:4096
    s_waitcnt lgkmcnt(6)
    v_mfma_f32_16x16x32_bf16 v[184:187], v[40:43], v[116:119], 0
    ds_read_b64_tr_b16 v[56:57], v28 offset:0
    ds_read_b64_tr_b16 v[58:59], v28 offset:4096
    s_waitcnt lgkmcnt(6)
    v_mfma_f32_16x16x32_bf16 v[180:183], v[44:47], v[132:135], v[180:183]
    ds_read_b64_tr_b16 v[60:61], v25 offset:0
    ds_read_b64_tr_b16 v[62:63], v25 offset:4096
    s_waitcnt lgkmcnt(6)
    v_mfma_f32_16x16x32_bf16 v[184:187], v[48:51], v[132:135], v[184:187]
    ds_read_b64_tr_b16 v[64:65], v29 offset:0
    ds_read_b64_tr_b16 v[66:67], v29 offset:4096
    s_waitcnt lgkmcnt(6)
    v_mfma_f32_16x16x32_bf16 v[180:183], v[52:55], v[148:151], v[180:183]
    s_waitcnt lgkmcnt(4)
    v_mfma_f32_16x16x32_bf16 v[184:187], v[56:59], v[148:151], v[184:187]
    s_waitcnt lgkmcnt(2)
    v_mfma_f32_16x16x32_bf16 v[180:183], v[60:63], v[164:167], v[180:183]
    s_waitcnt lgkmcnt(0)
    v_mfma_f32_16x16x32_bf16 v[184:187], v[64:67], v[164:167], v[184:187]
    s_mov_b32 s46, 1048576
L_fw7:
    ds_read_b32 v36, v8 offset:36
    s_waitcnt lgkmcnt(0)
    v_cmp_gt_u32 vcc, 1, v36
    s_cbranch_vccz L_fd8
    s_sleep 1
    s_sub_u32 s46, s46, 1
    s_cmp_lg_u32 s46, 0
    s_cbranch_scc1 L_fw7
L_fd8:
    ds_read_b64_tr_b16 v[36:37], v22 offset:8192
    ds_read_b64_tr_b16 v[38:39], v22 offset:12288
    ds_read_b64_tr_b16 v[40:41], v26 offset:8192
    ds_read_b64_tr_b16 v[42:43], v26 offset:12288
    ds_read_b64_tr_b16 v[44:45], v23 offset:8192
    ds_read_b64_tr_b16 v[46:47], v23 offset:12288
    ds_read_b64_tr_b16 v[48:49], v27 offset:8192
    ds_read_b64_tr_b16 v[50:51], v27 offset:12288
    v_mfma_f32_16x16x32_bf16 v[188:191], v[192:195], v[120:123], v[188:191]
    s_waitcnt lgkmcnt(6)
    v_mfma_f32_16x16x32_bf16 v[180:183], v[36:39], v[120:123], v[180:183]
    ds_read_b64_tr_b16 v[52:53], v24 offset:8192
    ds_read_b64_tr_b16 v[54:55], v24 offset:12288
    s_waitcnt lgkmcnt(6)
    v_mfma_f32_16x16x32_bf16 v[184:187], v[40:43], v[120:123], v[184:187]
    ds_read_b64_tr_b16 v[56:57], v28 offset:8192
    ds_read_b64_tr_b16 v[58:59], v28 offset:12288
    s_waitcnt lgkmcnt(6)
    v_mfma_f32_16x16x32_bf16 v[180:183], v[44:47], v[136:139], v[180:183]
    ds_read_b64_tr_b16 v[60:61], v25 offset:8192
    ds_read_b64_tr_b16 v[62:63], v25 offset:12288
    s_waitcnt lgkmcnt(6)
    v_mfma_f32_16x16x32_bf16 v[184:187], v[48:51], v[136:139], v[184:187]
    ds_read_b64_tr_b16 v[64:65], v29 offset:8192
    ds_read_b64_tr_b16 v[66:67], v29 offset:12288
    s_waitcnt lgkmcnt(6)
    v_mfma_f32_16x16x32_bf16 v[180:183], v[52:55], v[152:155], v[180:183]
    s_waitcnt lgkmcnt(4)
    v_mfma_f32_16x16x32_bf16 v[184:187], v[56:59], v[152:155], v[184:187]
    s_waitcnt lgkmcnt(2)
    v_mfma_f32_16x16x32_bf16 v[180:183], v[60:63], v[168:171], v[180:183]
    s_waitcnt lgkmcnt(0)
    v_mfma_f32_16x16x32_bf16 v[184:187], v[64:67], v[168:171], v[184:187]
    s_mov_b32 s46, 1048576
L_fw9:
    ds_read_b32 v36, v8 offset:24
    s_waitcnt lgkmcnt(0)
    v_cmp_gt_u32 vcc, 1, v36
    s_cbranch_vccz L_fd10
    s_sleep 1
    s_sub_u32 s46, s46, 1
    s_cmp_lg_u32 s46, 0
    s_cbranch_scc1 L_fw9
L_fd10:
    v_mul_u32_u24 v4, 528, v2
    v_add_u32 v229, s36, v4
    v_and_b32 v4, 3, v2
    v_mul_u32_u24 v4, 528, v4
    v_lshrrev_b32 v5, 2, v2
    v_lshl_add_u32 v4, v5, 6, v4
    v_lshl_add_u32 v4, v3, 4, v4
    v_add_u32 v228, s36, v4
    s_mul_i32 s42, s3, 528
    v_min_u32 v4, 32, v1
    v_lshlrev_b32 v4, 4, v4
    v_add_u32 v230, s42, v4
    v_add_u32 v231, 73728, v230
    s_lshl_b32 s42, s47, 11
    s_lshl_b32 s43, s3, 9
    s_add_u32 s42, s42, s43
    s_add_u32 s42, s42, 131072
    v_add_u32 v232, s42, v4
    s_lshl_b32 s42, s34, 2
    s_add_u32 s42, s42, s3
    s_lshl_b32 s42, s42, 5
    s_add_u32 s42, s42, s35
    s_lshl_b32 s42, s42, 7
    s_add_u32 s42, s42, 655360
    v_and_b32 v5, 7, v1
    v_lshlrev_b32 v5, 4, v5
    v_add_u32 v5, s42, v5
    v_cmp_le_u32 vcc, 32, v1
    s_nop 1
    v_cndmask_b32 v232, v232, v5, vcc
    v_readlane_b32 s51, v34, s3
    s_lshr_b32 s42, s3, 1
    s_lshr_b32 s44, s35, 3
    s_lshl_b32 s43, s34, 2
    s_add_u32 s43, s43, s44
    s_lshl_b32 s43, s43, 1
    s_add_u32 s43, s43, s42
    s_lshl_b32 s43, s43, 11
    s_add_u32 s43, s43, 655360
    v_lshrrev_b32 v4, 2, v1
    v_lshlrev_b32 v5, 7, v4
    v_add_u32 v234, s43, v5
    s_lshl_b32 s43, s34, 1
    s_add_u32 s43, s43, s42
    s_lshl_b32 s43, s43, 15
    s_lshl_b32 s44, s44, 9
    s_add_u32 s43, s43, s44
    s_lshr_b32 s45, s35, 1
    s_and_b32 s45, s45, 3
    s_lshl_b32 s45, s45, 7
    s_add_u32 s43, s43, s45
    s_and_b32 s45, s3, 1
    s_lshl_b32 s45, s45, 6
    s_add_u32 s43, s43, s45
    s_add_u32 s43, s43, 131072
    v_lshlrev_b32 v4, 11, v4
    v_and_b32 v5, 3, v1
    v_lshl_add_u32 v4, v5, 4, v4
    v_add_u32 v233, s43, v4
    v_and_b32 v4, 1, v3
    v_lshlrev_b32 v4, 1, v4
    v_lshrrev_b32 v6, 1, v3
    v_or_b32 v4, v4, v6
    v_lshl_add_u32 v4, v5, 2, v4
    v_lshlrev_b32 v4, 1, v4
    s_lshl_b32 s42, s42, 6
    s_and_b32 s43, s3, 1
    s_lshl_b32 s43, s43, 5
    s_add_u32 s42, s42, s43
    s_add_u32 s42, s42, 157056
    v_add_u32 v235, s42, v4
    s_lshl_b32 s42, s48, 1
    s_add_u32 s42, s42, s49
    s_lshl_b32 s42, s42, 11
    s_lshl_b32 s43, s3, 9
    s_add_u32 s42, s42, s43
    s_add_u32 s42, s42, 786432
    v_lshlrev_b32 v4, 7, v3
    v_lshl_add_u32 v4, v2, 4, v4
    v_add_u32 v236, s42, v4
    v_not_b32 v237, s33
    v_lshrrev_b32 v4, 2, v1
    v_lshrrev_b32 v5, 1, v4
    v_and_b32 v5, 3, v5
    v_lshlrev_b32 v5, 5, v5
    v_lshl_add_u32 v5, v4, 7, v5
    v_and_b32 v6, 3, v1
    v_lshl_add_u32 v5, v6, 3, v5
    s_lshl_b32 s42, s3, 11
    s_add_u32 s42, s42, 147456
    v_add_u32 v96, s42, v5
    v_xor_b32 v97, 32, v96
    v_xor_b32 v98, 64, v96
    v_xor_b32 v99, 96, v96
    v_lshrrev_b32 v4, 1, v2
    v_and_b32 v5, 1, v2
    v_lshlrev_b32 v6, 5, v5
    v_lshl_add_u32 v6, v3, 3, v6
    v_add_u32 v6, 156928, v6
    v_lshlrev_b32 v5, 6, v5
    v_lshl_add_u32 v5, v3, 4, v5
    v_add_u32 v5, 157056, v5
    v_mov_b32 v12, 156992
    v_cmp_eq_u32 vcc, 0, v4
    s_nop 1
    v_cndmask_b32 v92, v12, v5, vcc
    v_cndmask_b32 v11, v12, v6, vcc
    ds_read_b64 v[84:85], v11
    v_cmp_eq_u32 vcc, 1, v4
    s_nop 1
    v_cndmask_b32 v93, v12, v5, vcc
    v_cndmask_b32 v11, v12, v6, vcc
    ds_read_b64 v[86:87], v11
    v_cmp_eq_u32 vcc, 2, v4
    s_nop 1
    v_cndmask_b32 v94, v12, v5, vcc
    v_cndmask_b32 v11, v12, v6, vcc
    ds_read_b64 v[88:89], v11
    v_cmp_eq_u32 vcc, 3, v4
    s_nop 1
    v_cndmask_b32 v95, v12, v5, vcc
    v_cndmask_b32 v11, v12, v6, vcc
    ds_read_b64 v[90:91], v11
    s_lshr_b32 s42, s3, 1
    s_lshl_b32 s42, s42, 2
    s_add_u32 s42, s42, 157184
    v_mov_b32 v4, s42
    ds_read_b32 v227, v4
    v_mov_b32 v5, 157184
    ds_read_b32 v5, v5 offset:8
    s_waitcnt lgkmcnt(0)
    v_readfirstlane_b32 s52, v5
    s_mov_b32 s46, 1048576
L_fw11:
    ds_read_b32 v36, v8 offset:40
    s_waitcnt lgkmcnt(0)
    v_cmp_gt_u32 vcc, 1, v36
    s_cbranch_vccz L_fd12
    s_sleep 1
    s_sub_u32 s46, s46, 1
    s_cmp_lg_u32 s46, 0
    s_cbranch_scc1 L_fw11
L_fd12:
    ds_read_b64_tr_b16 v[36:37], v22 offset:16384
    ds_read_b64_tr_b16 v[38:39], v22 offset:20480
    ds_read_b64_tr_b16 v[40:41], v26 offset:16384
    ds_read_b64_tr_b16 v[42:43], v26 offset:20480
    ds_read_b64_tr_b16 v[44:45], v23 offset:16384
    ds_read_b64_tr_b16 v[46:47], v23 offset:20480
    ds_read_b64_tr_b16 v[48:49], v27 offset:16384
    ds_read_b64_tr_b16 v[50:51], v27 offset:20480
    v_mfma_f32_16x16x32_bf16 v[188:191], v[192:195], v[124:127], v[188:191]
    s_waitcnt lgkmcnt(6)
    v_mfma_f32_16x16x32_bf16 v[180:183], v[36:39], v[124:127], v[180:183]
    ds_read_b64_tr_b16 v[52:53], v24 offset:16384
    ds_read_b64_tr_b16 v[54:55], v24 offset:20480
    s_waitcnt lgkmcnt(6)
    v_mfma_f32_16x16x32_bf16 v[184:187], v[40:43], v[124:127], v[184:187]
    ds_read_b64_tr_b16 v[56:57], v28 offset:16384
    ds_read_b64_tr_b16 v[58:59], v28 offset:20480
    s_waitcnt lgkmcnt(6)
    v_mfma_f32_16x16x32_bf16 v[180:183], v[44:47], v[140:143], v[180:183]
    ds_read_b64_tr_b16 v[60:61], v25 offset:16384
    ds_read_b64_tr_b16 v[62:63], v25 offset:20480
    s_waitcnt lgkmcnt(6)
    v_mfma_f32_16x16x32_bf16 v[184:187], v[48:51], v[140:143], v[184:187]
    ds_read_b64_tr_b16 v[64:65], v29 offset:16384
    ds_read_b64_tr_b16 v[66:67], v29 offset:20480
    s_waitcnt lgkmcnt(6)
    v_mfma_f32_16x16x32_bf16 v[180:183], v[52:55], v[156:159], v[180:183]
    s_waitcnt lgkmcnt(4)
    v_mfma_f32_16x16x32_bf16 v[184:187], v[56:59], v[156:159], v[184:187]
    s_waitcnt lgkmcnt(2)
    v_mfma_f32_16x16x32_bf16 v[180:183], v[60:63], v[172:175], v[180:183]
    s_waitcnt lgkmcnt(0)
    v_mfma_f32_16x16x32_bf16 v[184:187], v[64:67], v[172:175], v[184:187]
    s_mov_b32 s46, 1048576
L_fw13:
    ds_read_b32 v36, v8 offset:44
    s_waitcnt lgkmcnt(0)
    v_cmp_gt_u32 vcc, 1, v36
    s_cbranch_vccz L_fd14
    s_sub_u32 s46, s46, 1
    s_cmp_lg_u32 s46, 0
    s_cbranch_scc1 L_fw13
L_fd14:
    ds_read_b64_tr_b16 v[36:37], v22 offset:24576
    ds_read_b64_tr_b16 v[38:39], v22 offset:28672
    ds_read_b64_tr_b16 v[40:41], v26 offset:24576
    ds_read_b64_tr_b16 v[42:43], v26 offset:28672
    ds_read_b64_tr_b16 v[44:45], v23 offset:24576
    ds_read_b64_tr_b16 v[46:47], v23 offset:28672
    ds_read_b64_tr_b16 v[48:49], v27 offset:24576
    ds_read_b64_tr_b16 v[50:51], v27 offset:28672
    v_mfma_f32_16x16x32_bf16 v[188:191], v[192:195], v[128:131], v[188:191]
    s_waitcnt lgkmcnt(6)
    v_mfma_f32_16x16x32_bf16 v[180:183], v[36:39], v[128:131], v[180:183]
    ds_read_b64_tr_b16 v[52:53], v24 offset:24576
    ds_read_b64_tr_b16 v[54:55], v24 offset:28672
    s_waitcnt lgkmcnt(6)
    v_mfma_f32_16x16x32_bf16 v[184:187], v[40:43], v[128:131], v[184:187]
    ds_read_b64_tr_b16 v[56:57], v28 offset:24576
    ds_read_b64_tr_b16 v[58:59], v28 offset:28672
    s_waitcnt lgkmcnt(6)
    v_mfma_f32_16x16x32_bf16 v[180:183], v[44:47], v[144:147], v[180:183]
    ds_read_b64_tr_b16 v[60:61], v25 offset:24576
    ds_read_b64_tr_b16 v[62:63], v25 offset:28672
    s_waitcnt lgkmcnt(6)
    v_mfma_f32_16x16x32_bf16 v[184:187], v[48:51], v[144:147], v[184:187]
    ds_read_b64_tr_b16 v[64:65], v29 offset:24576
    ds_read_b64_tr_b16 v[66:67], v29 offset:28672
    s_waitcnt lgkmcnt(6)
    v_mfma_f32_16x16x32_bf16 v[180:183], v[52:55], v[160:163], v[180:183]
    s_waitcnt lgkmcnt(4)
    v_mfma_f32_16x16x32_bf16 v[184:187], v[56:59], v[160:163], v[184:187]
    s_waitcnt lgkmcnt(2)
    v_mfma_f32_16x16x32_bf16 v[180:183], v[60:63], v[176:179], v[180:183]
    s_waitcnt lgkmcnt(0)
    v_mfma_f32_16x16x32_bf16 v[184:187], v[64:67], v[176:179], v[184:187]
    s_nop 5
    ds_write_b128 v228, v[180:183]
    s_nop 0
    ds_write_b128 v228, v[184:187] offset:256
    s_mov_b32 exec_lo, 0xf
    s_mov_b32 exec_hi, 0x0
    ds_write_b32 v229, v188 offset:512
    s_mov_b64 exec, -1
    s_waitcnt lgkmcnt(0)
    s_barrier
    s_mov_b32 exec_hi, 0xff
    ds_read_b128 v[36:39], v230
    ds_read_b128 v[40:43], v230 offset:36864
    ds_read_b128 v[44:47], v231
    ds_read_b128 v[48:51], v231 offset:36864
    s_waitcnt lgkmcnt(2)
    v_add_f32 v36, v36, v40
    v_add_f32 v37, v37, v41
    v_add_f32 v38, v38, v42
    v_add_f32 v39, v39, v43
    s_waitcnt lgkmcnt(0)
    v_add_f32 v44, v44, v48
    v_add_f32 v45, v45, v49
    v_add_f32 v46, v46, v50
    v_add_f32 v47, v47, v51
    v_add_f32 v36, v36, v44
    v_add_f32 v37, v37, v45
    v_add_f32 v38, v38, v46
    v_add_f32 v39, v39, v47
    v_mov_b32 v4, v36
    v_bfi_b32 v36, s33, v7, v36
    v_bfi_b32 v37, s33, v7, v37
    v_bfi_b32 v38, s33, v7, v38
    v_bfi_b32 v39, s33, v7, v39
    s_mov_b32 exec_lo, 0
    v_mov_b32 v36, s51
    v_mov_b32 v37, v4
    v_mov_b32 v38, s31
    v_mov_b32 v39, s32
    s_mov_b32 exec_lo, -1
    s_cmp_eq_u32 s52, 1
    s_cbranch_scc1 L_pub1_local
    buffer_store_dwordx4 v[36:39], v232, s[68:71], 0 offen sc1
    s_branch L_pub1_done
L_pub1_local:
    buffer_store_dwordx4 v[36:39], v232, s[68:71], 0 offen
L_pub1_done:
    s_mov_b64 exec, -1
    buffer_load_dwordx4 v[56:59], v234, s[68:71], 0 offen sc1
    buffer_load_dwordx4 v[52:55], v233, s[68:71], 0 offen sc1
    s_mov_b32 s46, 1048576
L_fw15:
    ds_read_b32 v68, v8 offset:28
    s_waitcnt lgkmcnt(0)
    v_cmp_gt_u32 vcc, 1, v68
    s_cbranch_vccz L_fd16
    s_sub_u32 s46, s46, 1
    s_cmp_lg_u32 s46, 0
    s_cbranch_scc1 L_fw15
L_fd16:
    ds_read_b64_tr_b16 v[196:197], v30 offset:32768
    ds_read_b64_tr_b16 v[198:199], v30 offset:33280
    ds_read_b64_tr_b16 v[200:201], v31 offset:32768
    ds_read_b64_tr_b16 v[202:203], v31 offset:33280
    ds_read_b64_tr_b16 v[204:205], v32 offset:32768
    ds_read_b64_tr_b16 v[206:207], v32 offset:33280
    ds_read_b64_tr_b16 v[208:209], v33 offset:32768
    ds_read_b64_tr_b16 v[210:211], v33 offset:33280
    ds_read_b64_tr_b16 v[212:213], v96
    ds_read_b64_tr_b16 v[214:215], v97
    ds_read_b64_tr_b16 v[216:217], v98
    ds_read_b64_tr_b16 v[218:219], v99
    s_waitcnt lgkmcnt(0)
    v_mfma_f32_16x16x16_bf16 v[220:223], v[212:213], v[84:85], 0
    v_mfma_f32_16x16x16_bf16 v[220:223], v[214:215], v[86:87], v[220:223]
    v_mfma_f32_16x16x16_bf16 v[220:223], v[216:217], v[88:89], v[220:223]
    v_mfma_f32_16x16x16_bf16 v[220:223], v[218:219], v[90:91], v[220:223]
    s_mov_b32 s46, 131072
L_h1:
    s_waitcnt vmcnt(0)
    v_bitop3_b32 v60, v52, v53, v7 bitop3:0x7e
    v_bitop3_b32 v61, v54, v55, v7 bitop3:0x7e
    v_or_b32 v60, v60, v61
    v_and_b32 v60, s33, v60
    v_xor_b32 v61, s31, v58
    v_xor_b32 v62, s32, v59
    v_or3_b32 v60, v60, v61, v62
    v_cmp_ne_u32 vcc, 0, v60
    s_cbranch_vccz L_h1_done
    s_mov_b64 exec, vcc
    s_sub_u32 s46, s46, 1
    s_cmp_lg_u32 s46, 0
    s_cbranch_scc0 L_h1_done
    buffer_load_dwordx4 v[56:59], v234, s[68:71], 0 offen sc1
    buffer_load_dwordx4 v[52:55], v233, s[68:71], 0 offen sc1
    s_branch L_h1
L_h1_done:
    s_mov_b64 exec, -1
    v_max_f32_dpp v44, v56, v56 row_ror:4 row_mask:0xf bank_mask:0xf
    v_and_b32 v52, v52, v237
    v_and_b32 v53, v53, v237
    v_max_f32_dpp v44, v44, v44 row_ror:8 row_mask:0xf bank_mask:0xf
    v_and_b32 v54, v54, v237
    v_mov_b32 v45, v44
    v_and_b32 v55, v55, v237
    s_nop 0
    v_permlane32_swap_b32 v44, v45
    v_max_f32 v44, v44, v45
    v_mov_b32 v45, v44
    s_nop 1
    v_permlane16_swap_b32 v44, v45
    v_max_f32 v44, v44, v45
    v_sub_f32 v46, v56, v44
    v_exp_f32 v46, v46
    s_nop 0
    v_mul_f32 v47, v46, v57
    v_mul_f32 v52, v46, v52
    v_mul_f32 v53, v46, v53
    v_mul_f32 v54, v46, v54
    v_mul_f32 v55, v46, v55
    v_mov_b32 v45, v47
    v_permlane32_swap_b32 v52, v53
    v_permlane32_swap_b32 v54, v55
    v_permlane32_swap_b32 v47, v45
    v_add_f32 v52, v52, v53
    v_add_f32 v54, v54, v55
    v_add_f32 v47, v47, v45
    v_mov_b32 v45, v47
    v_permlane16_swap_b32 v52, v54
    s_nop 0
    v_permlane16_swap_b32 v47, v45
    v_add_f32 v52, v52, v54
    v_add_f32 v47, v47, v45
    s_nop 0
    v_add_f32_dpp v52, v52, v52 row_ror:4 row_mask:0xf bank_mask:0xf
    v_add_f32_dpp v47, v47, v47 row_ror:4 row_mask:0xf bank_mask:0xf
    s_nop 0
    v_add_f32_dpp v52, v52, v52 row_ror:8 row_mask:0xf bank_mask:0xf
    v_add_f32_dpp v47, v47, v47 row_ror:8 row_mask:0xf bank_mask:0xf
    v_mul_f32 v52, v52, v227
    v_rcp_f32 v47, v47
    s_nop 0
    v_mul_f32 v52, v52, v47
    v_cvt_pk_bf16_f32 v52, v52, v52
    s_mov_b32 exec_lo, 0xf000f
    s_mov_b32 exec_hi, 0xf000f
    ds_write_b16 v235, v52
    s_mov_b64 exec, -1
    s_waitcnt lgkmcnt(0)
    s_barrier
    ds_read_b128 v[68:71], v92
    ds_read_b128 v[72:75], v93
    ds_read_b128 v[76:79], v94
    ds_read_b128 v[80:83], v95
    s_waitcnt lgkmcnt(3)
    v_mfma_f32_16x16x32_bf16 v[220:223], v[196:199], v[68:71], v[220:223]
    s_waitcnt lgkmcnt(2)
    v_mfma_f32_16x16x32_bf16 v[220:223], v[200:203], v[72:75], v[220:223]
    s_waitcnt lgkmcnt(1)
    v_mfma_f32_16x16x32_bf16 v[220:223], v[204:207], v[76:79], v[220:223]
    s_waitcnt lgkmcnt(0)
    v_mfma_f32_16x16x32_bf16 v[220:223], v[208:211], v[80:83], v[220:223]
    s_lshr_b32 s42, s2, 5
    s_lshl_b32 s42, s42, 11
    s_lshr_b32 s43, s2, 3
    s_and_b32 s43, s43, 3
    s_lshl_b32 s43, s43, 9
    s_add_u32 s42, s42, s43
    s_lshr_b32 s43, s2, 1
    s_and_b32 s43, s43, 3
    s_lshl_b32 s43, s43, 7
    s_add_u32 s42, s42, s43
    s_and_b32 s43, s2, 1
    s_lshl_b32 s43, s43, 6
    s_add_u32 s42, s42, s43
    s_add_u32 s42, s42, 786432
    v_lshrrev_b32 v4, 2, v0
    v_lshlrev_b32 v4, 12, v4
    v_and_b32 v5, 3, v0
    v_lshl_add_u32 v4, v5, 4, v4
    v_add_u32 v233, s42, v4
    v_bfi_b32 v220, s33, v7, v220
    v_bfi_b32 v221, s33, v7, v221
    v_bfi_b32 v222, s33, v7, v222
    v_bfi_b32 v223, s33, v7, v223
    s_mov_b32 exec_lo, 0xff00ff
    s_mov_b32 exec_hi, 0xff00ff
    buffer_store_dwordx4 v[220:223], v236, s[68:71], 0 offen sc1
    s_mov_b64 exec, -1
    s_cmp_ge_u32 s2, 64
    s_cbranch_scc1 L_end
    s_mov_b32 s45, 262144
    buffer_load_dwordx4 v[36:39], v233, s[68:71], 0 offen sc1
    buffer_load_dwordx4 v[40:43], v233, s[68:71], s45 offen sc1
    v_and_b32 v4, 1, v3
    v_lshlrev_b32 v4, 1, v4
    v_lshrrev_b32 v5, 1, v3
    v_or_b32 v4, v4, v5
    v_and_b32 v5, 3, v1
    v_lshl_add_u32 v4, v5, 2, v4
    v_lshlrev_b32 v4, 2, v4
    s_lshl_b32 s42, s3, 6
    s_add_u32 s42, s42, 157376
    v_add_u32 v234, s42, v4
    v_lshlrev_b32 v5, 4, v5
    v_add_u32 v235, 157376, v5
    s_lshr_b32 s42, s2, 5
    s_lshl_b32 s42, s42, 9
    s_lshr_b32 s43, s2, 3
    s_and_b32 s43, s43, 3
    s_lshl_b32 s43, s43, 7
    s_add_u32 s42, s42, s43
    s_and_b32 s43, s2, 1
    s_lshl_b32 s43, s43, 6
    s_add_u32 s42, s42, s43
    s_lshr_b32 s43, s2, 1
    s_and_b32 s43, s43, 3
    s_lshl_b32 s43, s43, 3
    s_add_u32 s42, s42, s43
    v_and_b32 v4, 1, v1
    v_lshlrev_b32 v4, 10, v4
    v_bfe_u32 v5, v1, 1, 1
    v_lshl_add_u32 v4, v5, 5, v4
    v_add_u32 v232, s42, v4
    s_mov_b32 s72, s24
    s_mov_b32 s73, s25
    s_mov_b32 s74, 2048
    s_mov_b32 s75, 0x20000
    s_mov_b32 s46, 131072
L_h2:
    s_waitcnt vmcnt(0)
    v_bitop3_b32 v44, v36, v37, v7 bitop3:0x7e
    v_bitop3_b32 v45, v38, v39, v7 bitop3:0x7e
    v_bitop3_b32 v46, v40, v41, v7 bitop3:0x7e
    v_bitop3_b32 v47, v42, v43, v7 bitop3:0x7e
    v_or3_b32 v44, v44, v45, v46
    v_or_b32 v44, v44, v47
    v_and_b32 v44, s33, v44
    v_cmp_ne_u32 vcc, 0, v44
    s_cbranch_vccz L_h2_done
    s_mov_b64 exec, vcc
    s_sub_u32 s46, s46, 1
    s_cmp_lg_u32 s46, 0
    s_cbranch_scc0 L_h2_done
    buffer_load_dwordx4 v[36:39], v233, s[68:71], 0 offen sc1
    buffer_load_dwordx4 v[40:43], v233, s[68:71], s45 offen sc1
    s_branch L_h2
L_h2_done:
    s_mov_b64 exec, -1
    v_and_b32 v52, v36, v237
    v_and_b32 v56, v40, v237
    v_and_b32 v53, v37, v237
    v_and_b32 v57, v41, v237
    v_and_b32 v54, v38, v237
    v_and_b32 v58, v42, v237
    v_and_b32 v55, v39, v237
    v_and_b32 v59, v43, v237
    v_add_f32 v52, v52, v56
    v_add_f32 v53, v53, v57
    v_add_f32 v54, v54, v58
    v_add_f32 v55, v55, v59
    v_permlane32_swap_b32 v52, v53
    s_nop 0
    v_permlane32_swap_b32 v54, v55
    v_add_f32 v52, v52, v53
    v_add_f32 v54, v54, v55
    s_nop 1
    v_permlane16_swap_b32 v52, v54
    v_add_f32 v52, v52, v54
    s_nop 1
    v_add_f32_dpp v52, v52, v52 row_ror:4 row_mask:0xf bank_mask:0xf
    s_nop 1
    v_add_f32_dpp v52, v52, v52 row_ror:8 row_mask:0xf bank_mask:0xf
    s_mov_b32 exec_lo, 0xf000f
    s_mov_b32 exec_hi, 0xf000f
    ds_write_b32 v234, v52
    s_mov_b64 exec, -1
    s_waitcnt lgkmcnt(0)
    s_barrier
    s_cmp_lg_u32 s3, 0
    s_cbranch_scc1 L_end
    s_mov_b32 exec_lo, 0xf
    s_mov_b32 exec_hi, 0x0
    ds_read_b128 v[68:71], v235
    ds_read_b128 v[72:75], v235 offset:64
    ds_read_b128 v[76:79], v235 offset:128
    ds_read_b128 v[80:83], v235 offset:192
    s_waitcnt lgkmcnt(2)
    v_add_f32 v68, v68, v72
    v_add_f32 v69, v69, v73
    v_add_f32 v70, v70, v74
    v_add_f32 v71, v71, v75
    s_waitcnt lgkmcnt(0)
    v_add_f32 v76, v76, v80
    v_add_f32 v77, v77, v81
    v_add_f32 v78, v78, v82
    v_add_f32 v79, v79, v83
    v_add_f32 v68, v68, v76
    v_add_f32 v69, v69, v77
    v_add_f32 v70, v70, v78
    v_add_f32 v71, v71, v79
    v_cvt_pk_bf16_f32 v68, v68, v69
    v_cvt_pk_bf16_f32 v69, v70, v71
    buffer_store_dwordx2 v[68:69], v232, s[72:75], 0 offen
    s_cmp_lg_u32 s2, 0
    s_cbranch_scc1 L_end
    s_mov_b32 exec_lo, 1
    v_mov_b32 v4, 0
    v_mov_b32 v5, s31
    buffer_store_dword v5, v4, s[68:71], 0 offen sc1
    s_endpgm
L_loader:
    v_lshlrev_b32 v4, 8, v3
    v_lshlrev_b32 v5, 1, v3
    v_xor_b32 v5, v2, v5
    v_lshl_add_u32 v10, v5, 4, v4
    v_xor_b32 v11, 128, v10
    v_mov_b32 v12, 0
    v_mov_b32 v13, 0
    v_mov_b32 v14, 0
    v_mov_b32 v15, 0
    ds_write_b128 v8, v[12:15]
    ds_write_b128 v8, v[12:15] offset:16
    ds_write_b128 v8, v[12:15] offset:32
    ds_write_b128 v8, v[12:15] offset:48
    ds_write_b128 v8, v[12:15] offset:64
    ds_write_b128 v8, v[12:15] offset:80
    v_mov_b32 v16, 156992
    ds_write_b128 v16, v[12:15]
    s_waitcnt lgkmcnt(0)
    s_add_u32 s56, s8, s45
    s_addc_u32 s57, s9, 0
    s_mov_b32 s58, 131072
    s_mov_b32 s59, 0x20000
    s_lshr_b32 s42, s35, 4
    s_lshl_b32 s43, s34, 1
    s_add_u32 s43, s43, s42
    s_lshl_b32 s43, s43, 4
    s_and_b32 s44, s35, 15
    s_add_u32 s47, s43, s44
    s_lshr_b32 s42, s35, 1
    s_lshl_b32 s48, s34, 4
    s_add_u32 s48, s48, s42
    s_and_b32 s49, s35, 1
    s_mul_i32 s50, s48, 14
    s_and_b32 s50, s50, -4
    s_lshl_b32 s42, s48, 15
    s_lshl_b32 s43, s49, 9
    s_add_u32 s42, s42, s43
    s_add_u32 s60, s12, s42
    s_addc_u32 s61, s13, 0
    s_mov_b32 s62, 32256
    s_mov_b32 s63, 0x20000
    s_lshl_b32 s42, s50, 10
    s_add_u32 s42, s42, s43
    s_add_u32 s64, s20, s42
    s_addc_u32 s65, s21, 0
    s_mov_b32 s66, 15872
    s_mov_b32 s67, 0x20000
    v_lshrrev_b32 v4, 3, v1
    v_and_b32 v5, 7, v1
    v_and_b32 v6, 2, v4
    v_xor_b32 v5, v5, v6
    v_lshlrev_b32 v5, 4, v5
    v_lshl_add_u32 v34, v4, 10, v5
    v_xor_b32 v35, 64, v34
    v_and_b32 v5, 7, v1
    v_and_b32 v6, 6, v4
    v_xor_b32 v5, v5, v6
    v_lshlrev_b32 v5, 4, v5
    v_lshl_add_u32 v36, v4, 10, v5
    s_barrier
    s_mov_b32 s46, 1048576
L_fw17:
    ds_read_b128 v[12:15], v8 offset:0
    s_waitcnt lgkmcnt(0)
    v_min_u32 v12, v12, v13
    v_min3_u32 v12, v12, v14, v15
    v_cmp_gt_u32 vcc, 1, v12
    s_cbranch_vccz L_fd18
    s_sleep 1
    s_sub_u32 s46, s46, 1
    s_cmp_lg_u32 s46, 0
    s_cbranch_scc1 L_fw17
L_fd18:
    s_mov_b32 m0, 0
    s_nop 0
    buffer_load_dwordx4 v10, s[56:59], 0 offen nt lds
    s_mov_b32 m0, 1024
    s_mov_b32 s37, 4096
    buffer_load_dwordx4 v11, s[56:59], s37 offen nt lds
    s_mov_b32 m0, 2048
    s_mov_b32 s37, 8192
    buffer_load_dwordx4 v10, s[56:59], s37 offen nt lds
    s_mov_b32 m0, 3072
    s_mov_b32 s37, 12288
    buffer_load_dwordx4 v11, s[56:59], s37 offen nt lds
    s_mov_b32 m0, 36864
    s_mov_b32 s37, 1024
    buffer_load_dwordx4 v10, s[56:59], s37 offen nt lds
    s_mov_b32 m0, 37888
    s_mov_b32 s37, 5120
    buffer_load_dwordx4 v11, s[56:59], s37 offen nt lds
    s_mov_b32 m0, 38912
    s_mov_b32 s37, 9216
    buffer_load_dwordx4 v10, s[56:59], s37 offen nt lds
    s_mov_b32 m0, 39936
    s_mov_b32 s37, 13312
    buffer_load_dwordx4 v11, s[56:59], s37 offen nt lds
    s_mov_b32 m0, 73728
    s_mov_b32 s37, 2048
    buffer_load_dwordx4 v10, s[56:59], s37 offen nt lds
    s_mov_b32 m0, 74752
    s_mov_b32 s37, 6144
    buffer_load_dwordx4 v11, s[56:59], s37 offen nt lds
    s_mov_b32 m0, 75776
    s_mov_b32 s37, 10240
    buffer_load_dwordx4 v10, s[56:59], s37 offen nt lds
    s_mov_b32 m0, 76800
    s_mov_b32 s37, 14336
    buffer_load_dwordx4 v11, s[56:59], s37 offen nt lds
    s_mov_b32 m0, 110592
    s_mov_b32 s37, 3072
    buffer_load_dwordx4 v10, s[56:59], s37 offen nt lds
    s_mov_b32 m0, 111616
    s_mov_b32 s37, 7168
    buffer_load_dwordx4 v11, s[56:59], s37 offen nt lds
    s_mov_b32 m0, 112640
    s_mov_b32 s37, 11264
    buffer_load_dwordx4 v10, s[56:59], s37 offen nt lds
    s_mov_b32 m0, 113664
    s_mov_b32 s37, 15360
    buffer_load_dwordx4 v11, s[56:59], s37 offen nt lds
    s_mov_b32 s46, 1048576
L_fw19:
    ds_read_b128 v[12:15], v8 offset:0
    s_waitcnt lgkmcnt(0)
    v_min_u32 v12, v12, v13
    v_min3_u32 v12, v12, v14, v15
    v_cmp_gt_u32 vcc, 2, v12
    s_cbranch_vccz L_fd20
    s_sleep 1
    s_sub_u32 s46, s46, 1
    s_cmp_lg_u32 s46, 0
    s_cbranch_scc1 L_fw19
L_fd20:
    s_mov_b32 m0, 4096
    s_mov_b32 s37, 16384
    buffer_load_dwordx4 v10, s[56:59], s37 offen nt lds
    s_mov_b32 m0, 5120
    s_mov_b32 s37, 20480
    buffer_load_dwordx4 v11, s[56:59], s37 offen nt lds
    s_mov_b32 m0, 6144
    s_mov_b32 s37, 24576
    buffer_load_dwordx4 v10, s[56:59], s37 offen nt lds
    s_mov_b32 m0, 7168
    s_mov_b32 s37, 28672
    buffer_load_dwordx4 v11, s[56:59], s37 offen nt lds
    s_mov_b32 m0, 40960
    s_mov_b32 s37, 17408
    buffer_load_dwordx4 v10, s[56:59], s37 offen nt lds
    s_mov_b32 m0, 41984
    s_mov_b32 s37, 21504
    buffer_load_dwordx4 v11, s[56:59], s37 offen nt lds
    s_mov_b32 m0, 43008
    s_mov_b32 s37, 25600
    buffer_load_dwordx4 v10, s[56:59], s37 offen nt lds
    s_mov_b32 m0, 44032
    s_mov_b32 s37, 29696
    buffer_load_dwordx4 v11, s[56:59], s37 offen nt lds
    s_mov_b32 m0, 77824
    s_mov_b32 s37, 18432
    buffer_load_dwordx4 v10, s[56:59], s37 offen nt lds
    s_mov_b32 m0, 78848
    s_mov_b32 s37, 22528
    buffer_load_dwordx4 v11, s[56:59], s37 offen nt lds
    s_mov_b32 m0, 79872
    s_mov_b32 s37, 26624
    buffer_load_dwordx4 v10, s[56:59], s37 offen nt lds
    s_mov_b32 m0, 80896
    s_mov_b32 s37, 30720
    buffer_load_dwordx4 v11, s[56:59], s37 offen nt lds
    s_mov_b32 m0, 114688
    s_mov_b32 s37, 19456
    buffer_load_dwordx4 v10, s[56:59], s37 offen nt lds
    s_mov_b32 m0, 115712
    s_mov_b32 s37, 23552
    buffer_load_dwordx4 v11, s[56:59], s37 offen nt lds
    s_mov_b32 m0, 116736
    s_mov_b32 s37, 27648
    buffer_load_dwordx4 v10, s[56:59], s37 offen nt lds
    s_mov_b32 m0, 117760
    s_mov_b32 s37, 31744
    buffer_load_dwordx4 v11, s[56:59], s37 offen nt lds
    s_mov_b32 s46, 1048576
L_fw21:
    ds_read_b128 v[12:15], v8 offset:0
    s_waitcnt lgkmcnt(0)
    v_min_u32 v12, v12, v13
    v_min3_u32 v12, v12, v14, v15
    v_cmp_gt_u32 vcc, 3, v12
    s_cbranch_vccz L_fd22
    s_sleep 1
    s_sub_u32 s46, s46, 1
    s_cmp_lg_u32 s46, 0
    s_cbranch_scc1 L_fw21
L_fd22:
    s_mov_b32 m0, 8192
    s_mov_b32 s37, 32768
    buffer_load_dwordx4 v10, s[56:59], s37 offen nt lds
    s_mov_b32 m0, 9216
    s_mov_b32 s37, 36864
    buffer_load_dwordx4 v11, s[56:59], s37 offen nt lds
    s_mov_b32 m0, 10240
    s_mov_b32 s37, 40960
    buffer_load_dwordx4 v10, s[56:59], s37 offen nt lds
    s_mov_b32 m0, 11264
    s_mov_b32 s37, 45056
    buffer_load_dwordx4 v11, s[56:59], s37 offen nt lds
    s_mov_b32 m0, 45056
    s_mov_b32 s37, 33792
    buffer_load_dwordx4 v10, s[56:59], s37 offen nt lds
    s_mov_b32 m0, 46080
    s_mov_b32 s37, 37888
    buffer_load_dwordx4 v11, s[56:59], s37 offen nt lds
    s_mov_b32 m0, 47104
    s_mov_b32 s37, 41984
    buffer_load_dwordx4 v10, s[56:59], s37 offen nt lds
    s_mov_b32 m0, 48128
    s_mov_b32 s37, 46080
    buffer_load_dwordx4 v11, s[56:59], s37 offen nt lds
    s_mov_b32 m0, 81920
    s_mov_b32 s37, 34816
    buffer_load_dwordx4 v10, s[56:59], s37 offen nt lds
    s_mov_b32 m0, 82944
    s_mov_b32 s37, 38912
    buffer_load_dwordx4 v11, s[56:59], s37 offen nt lds
    s_mov_b32 m0, 83968
    s_mov_b32 s37, 43008
    buffer_load_dwordx4 v10, s[56:59], s37 offen nt lds
    s_mov_b32 m0, 84992
    s_mov_b32 s37, 47104
    buffer_load_dwordx4 v11, s[56:59], s37 offen nt lds
    s_mov_b32 m0, 118784
    s_mov_b32 s37, 35840
    buffer_load_dwordx4 v10, s[56:59], s37 offen nt lds
    s_mov_b32 m0, 119808
    s_mov_b32 s37, 39936
    buffer_load_dwordx4 v11, s[56:59], s37 offen nt lds
    s_mov_b32 m0, 120832
    s_mov_b32 s37, 44032
    buffer_load_dwordx4 v10, s[56:59], s37 offen nt lds
    s_mov_b32 m0, 121856
    s_mov_b32 s37, 48128
    buffer_load_dwordx4 v11, s[56:59], s37 offen nt lds
    s_waitcnt vmcnt(32)
    s_mov_b32 m0, 12288
    s_mov_b32 s37, 49152
    buffer_load_dwordx4 v10, s[56:59], s37 offen nt lds
    s_mov_b32 m0, 13312
    s_mov_b32 s37, 53248
    buffer_load_dwordx4 v11, s[56:59], s37 offen nt lds
    s_mov_b32 m0, 14336
    s_mov_b32 s37, 57344
    buffer_load_dwordx4 v10, s[56:59], s37 offen nt lds
    s_mov_b32 m0, 15360
    s_mov_b32 s37, 61440
    buffer_load_dwordx4 v11, s[56:59], s37 offen nt lds
    s_mov_b32 m0, 49152
    s_mov_b32 s37, 50176
    buffer_load_dwordx4 v10, s[56:59], s37 offen nt lds
    s_mov_b32 m0, 50176
    s_mov_b32 s37, 54272
    buffer_load_dwordx4 v11, s[56:59], s37 offen nt lds
    s_mov_b32 m0, 51200
    s_mov_b32 s37, 58368
    buffer_load_dwordx4 v10, s[56:59], s37 offen nt lds
    s_mov_b32 m0, 52224
    s_mov_b32 s37, 62464
    buffer_load_dwordx4 v11, s[56:59], s37 offen nt lds
    s_mov_b32 m0, 86016
    s_mov_b32 s37, 51200
    buffer_load_dwordx4 v10, s[56:59], s37 offen nt lds
    s_mov_b32 m0, 87040
    s_mov_b32 s37, 55296
    buffer_load_dwordx4 v11, s[56:59], s37 offen nt lds
    s_mov_b32 m0, 88064
    s_mov_b32 s37, 59392
    buffer_load_dwordx4 v10, s[56:59], s37 offen nt lds
    s_mov_b32 m0, 89088
    s_mov_b32 s37, 63488
    buffer_load_dwordx4 v11, s[56:59], s37 offen nt lds
    s_mov_b32 m0, 122880
    s_mov_b32 s37, 52224
    buffer_load_dwordx4 v10, s[56:59], s37 offen nt lds
    s_mov_b32 m0, 123904
    s_mov_b32 s37, 56320
    buffer_load_dwordx4 v11, s[56:59], s37 offen nt lds
    s_mov_b32 m0, 124928
    s_mov_b32 s37, 60416
    buffer_load_dwordx4 v10, s[56:59], s37 offen nt lds
    s_mov_b32 m0, 125952
    s_mov_b32 s37, 64512
    buffer_load_dwordx4 v11, s[56:59], s37 offen nt lds
    s_waitcnt vmcnt(32)
    v_mov_b32 v16, 1
    ds_write_b32 v8, v16 offset:32
    s_mov_b32 m0, 16384
    s_mov_b32 s37, 65536
    buffer_load_dwordx4 v10, s[56:59], s37 offen nt lds
    s_mov_b32 m0, 17408
    s_mov_b32 s37, 69632
    buffer_load_dwordx4 v11, s[56:59], s37 offen nt lds
    s_mov_b32 m0, 18432
    s_mov_b32 s37, 73728
    buffer_load_dwordx4 v10, s[56:59], s37 offen nt lds
    s_mov_b32 m0, 19456
    s_mov_b32 s37, 77824
    buffer_load_dwordx4 v11, s[56:59], s37 offen nt lds
    s_mov_b32 m0, 53248
    s_mov_b32 s37, 66560
    buffer_load_dwordx4 v10, s[56:59], s37 offen nt lds
    s_mov_b32 m0, 54272
    s_mov_b32 s37, 70656
    buffer_load_dwordx4 v11, s[56:59], s37 offen nt lds
    s_mov_b32 m0, 55296
    s_mov_b32 s37, 74752
    buffer_load_dwordx4 v10, s[56:59], s37 offen nt lds
    s_mov_b32 m0, 56320
    s_mov_b32 s37, 78848
    buffer_load_dwordx4 v11, s[56:59], s37 offen nt lds
    s_mov_b32 m0, 90112
    s_mov_b32 s37, 67584
    buffer_load_dwordx4 v10, s[56:59], s37 offen nt lds
    s_mov_b32 m0, 91136
    s_mov_b32 s37, 71680
    buffer_load_dwordx4 v11, s[56:59], s37 offen nt lds
    s_mov_b32 m0, 92160
    s_mov_b32 s37, 75776
    buffer_load_dwordx4 v10, s[56:59], s37 offen nt lds
    s_mov_b32 m0, 93184
    s_mov_b32 s37, 79872
    buffer_load_dwordx4 v11, s[56:59], s37 offen nt lds
    s_mov_b32 m0, 126976
    s_mov_b32 s37, 68608
    buffer_load_dwordx4 v10, s[56:59], s37 offen nt lds
    s_mov_b32 m0, 128000
    s_mov_b32 s37, 72704
    buffer_load_dwordx4 v11, s[56:59], s37 offen nt lds
    s_mov_b32 m0, 129024
    s_mov_b32 s37, 76800
    buffer_load_dwordx4 v10, s[56:59], s37 offen nt lds
    s_mov_b32 m0, 130048
    s_mov_b32 s37, 80896
    buffer_load_dwordx4 v11, s[56:59], s37 offen nt lds
    s_waitcnt vmcnt(32)
    s_mov_b32 m0, 20480
    s_mov_b32 s37, 81920
    buffer_load_dwordx4 v10, s[56:59], s37 offen nt lds
    s_mov_b32 m0, 21504
    s_mov_b32 s37, 86016
    buffer_load_dwordx4 v11, s[56:59], s37 offen nt lds
    s_mov_b32 m0, 22528
    s_mov_b32 s37, 90112
    buffer_load_dwordx4 v10, s[56:59], s37 offen nt lds
    s_mov_b32 m0, 23552
    s_mov_b32 s37, 94208
    buffer_load_dwordx4 v11, s[56:59], s37 offen nt lds
    s_mov_b32 m0, 57344
    s_mov_b32 s37, 82944
    buffer_load_dwordx4 v10, s[56:59], s37 offen nt lds
    s_mov_b32 m0, 58368
    s_mov_b32 s37, 87040
    buffer_load_dwordx4 v11, s[56:59], s37 offen nt lds
    s_mov_b32 m0, 59392
    s_mov_b32 s37, 91136
    buffer_load_dwordx4 v10, s[56:59], s37 offen nt lds
    s_mov_b32 m0, 60416
    s_mov_b32 s37, 95232
    buffer_load_dwordx4 v11, s[56:59], s37 offen nt lds
    s_mov_b32 m0, 94208
    s_mov_b32 s37, 83968
    buffer_load_dwordx4 v10, s[56:59], s37 offen nt lds
    s_mov_b32 m0, 95232
    s_mov_b32 s37, 88064
    buffer_load_dwordx4 v11, s[56:59], s37 offen nt lds
    s_mov_b32 m0, 96256
    s_mov_b32 s37, 92160
    buffer_load_dwordx4 v10, s[56:59], s37 offen nt lds
    s_mov_b32 m0, 97280
    s_mov_b32 s37, 96256
    buffer_load_dwordx4 v11, s[56:59], s37 offen nt lds
    s_mov_b32 m0, 131072
    s_mov_b32 s37, 84992
    buffer_load_dwordx4 v10, s[56:59], s37 offen nt lds
    s_mov_b32 m0, 132096
    s_mov_b32 s37, 89088
    buffer_load_dwordx4 v11, s[56:59], s37 offen nt lds
    s_mov_b32 m0, 133120
    s_mov_b32 s37, 93184
    buffer_load_dwordx4 v10, s[56:59], s37 offen nt lds
    s_mov_b32 m0, 134144
    s_mov_b32 s37, 97280
    buffer_load_dwordx4 v11, s[56:59], s37 offen nt lds
    s_waitcnt vmcnt(32)
    v_mov_b32 v16, 1
    ds_write_b32 v8, v16 offset:36
    s_mov_b32 s46, 1048576
L_fw23:
    ds_read_b32 v12, v8 offset:16
    s_waitcnt lgkmcnt(0)
    v_cmp_gt_u32 vcc, 1, v12
    s_cbranch_vccz L_fd24
    s_sleep 1
    s_sub_u32 s46, s46, 1
    s_cmp_lg_u32 s46, 0
    s_cbranch_scc1 L_fw23
L_fd24:
    s_mov_b32 m0, 24576
    s_mov_b32 s37, 98304
    buffer_load_dwordx4 v10, s[56:59], s37 offen nt lds
    s_mov_b32 m0, 25600
    s_mov_b32 s37, 102400
    buffer_load_dwordx4 v11, s[56:59], s37 offen nt lds
    s_mov_b32 m0, 26624
    s_mov_b32 s37, 106496
    buffer_load_dwordx4 v10, s[56:59], s37 offen nt lds
    s_mov_b32 m0, 27648
    s_mov_b32 s37, 110592
    buffer_load_dwordx4 v11, s[56:59], s37 offen nt lds
    s_mov_b32 m0, 61440
    s_mov_b32 s37, 99328
    buffer_load_dwordx4 v10, s[56:59], s37 offen nt lds
    s_mov_b32 m0, 62464
    s_mov_b32 s37, 103424
    buffer_load_dwordx4 v11, s[56:59], s37 offen nt lds
    s_mov_b32 m0, 63488
    s_mov_b32 s37, 107520
    buffer_load_dwordx4 v10, s[56:59], s37 offen nt lds
    s_mov_b32 m0, 64512
    s_mov_b32 s37, 111616
    buffer_load_dwordx4 v11, s[56:59], s37 offen nt lds
    s_mov_b32 m0, 98304
    s_mov_b32 s37, 100352
    buffer_load_dwordx4 v10, s[56:59], s37 offen nt lds
    s_mov_b32 m0, 99328
    s_mov_b32 s37, 104448
    buffer_load_dwordx4 v11, s[56:59], s37 offen nt lds
    s_mov_b32 m0, 100352
    s_mov_b32 s37, 108544
    buffer_load_dwordx4 v10, s[56:59], s37 offen nt lds
    s_mov_b32 m0, 101376
    s_mov_b32 s37, 112640
    buffer_load_dwordx4 v11, s[56:59], s37 offen nt lds
    s_mov_b32 m0, 135168
    s_mov_b32 s37, 101376
    buffer_load_dwordx4 v10, s[56:59], s37 offen nt lds
    s_mov_b32 m0, 136192
    s_mov_b32 s37, 105472
    buffer_load_dwordx4 v11, s[56:59], s37 offen nt lds
    s_mov_b32 m0, 137216
    s_mov_b32 s37, 109568
    buffer_load_dwordx4 v10, s[56:59], s37 offen nt lds
    s_mov_b32 m0, 138240
    s_mov_b32 s37, 113664
    buffer_load_dwordx4 v11, s[56:59], s37 offen nt lds
    s_waitcnt vmcnt(32)
    s_mov_b32 m0, 28672
    s_mov_b32 s37, 114688
    buffer_load_dwordx4 v10, s[56:59], s37 offen nt lds
    s_mov_b32 m0, 29696
    s_mov_b32 s37, 118784
    buffer_load_dwordx4 v11, s[56:59], s37 offen nt lds
    s_mov_b32 m0, 30720
    s_mov_b32 s37, 122880
    buffer_load_dwordx4 v10, s[56:59], s37 offen nt lds
    s_mov_b32 m0, 31744
    s_mov_b32 s37, 126976
    buffer_load_dwordx4 v11, s[56:59], s37 offen nt lds
    s_mov_b32 m0, 65536
    s_mov_b32 s37, 115712
    buffer_load_dwordx4 v10, s[56:59], s37 offen nt lds
    s_mov_b32 m0, 66560
    s_mov_b32 s37, 119808
    buffer_load_dwordx4 v11, s[56:59], s37 offen nt lds
    s_mov_b32 m0, 67584
    s_mov_b32 s37, 123904
    buffer_load_dwordx4 v10, s[56:59], s37 offen nt lds
    s_mov_b32 m0, 68608
    s_mov_b32 s37, 128000
    buffer_load_dwordx4 v11, s[56:59], s37 offen nt lds
    s_mov_b32 m0, 102400
    s_mov_b32 s37, 116736
    buffer_load_dwordx4 v10, s[56:59], s37 offen nt lds
    s_mov_b32 m0, 103424
    s_mov_b32 s37, 120832
    buffer_load_dwordx4 v11, s[56:59], s37 offen nt lds
    s_mov_b32 m0, 104448
    s_mov_b32 s37, 124928
    buffer_load_dwordx4 v10, s[56:59], s37 offen nt lds
    s_mov_b32 m0, 105472
    s_mov_b32 s37, 129024
    buffer_load_dwordx4 v11, s[56:59], s37 offen nt lds
    s_mov_b32 m0, 139264
    s_mov_b32 s37, 117760
    buffer_load_dwordx4 v10, s[56:59], s37 offen nt lds
    s_mov_b32 m0, 140288
    s_mov_b32 s37, 121856
    buffer_load_dwordx4 v11, s[56:59], s37 offen nt lds
    s_mov_b32 m0, 141312
    s_mov_b32 s37, 125952
    buffer_load_dwordx4 v10, s[56:59], s37 offen nt lds
    s_mov_b32 m0, 142336
    s_mov_b32 s37, 130048
    buffer_load_dwordx4 v11, s[56:59], s37 offen nt lds
    s_waitcnt vmcnt(32)
    v_mov_b32 v16, 1
    ds_write_b32 v8, v16 offset:40
    s_waitcnt vmcnt(16)
    s_mov_b32 s46, 1048576
L_fw25:
    ds_read_b128 v[12:15], v8 offset:0
    s_waitcnt lgkmcnt(0)
    v_min_u32 v12, v12, v13
    v_min3_u32 v12, v12, v14, v15
    v_cmp_gt_u32 vcc, 4, v12
    s_cbranch_vccz L_fd26
    s_sleep 1
    s_sub_u32 s46, s46, 1
    s_cmp_lg_u32 s46, 0
    s_cbranch_scc1 L_fw25
L_fd26:
    s_mov_b32 m0, 32768
    s_nop 0
    buffer_load_dwordx4 v34, s[60:63], 0 offen nt lds
    s_mov_b32 m0, 33792
    s_mov_b32 s37, 8192
    buffer_load_dwordx4 v35, s[60:63], s37 offen nt lds
    s_mov_b32 m0, 34816
    s_mov_b32 s37, 16384
    buffer_load_dwordx4 v34, s[60:63], s37 offen nt lds
    s_mov_b32 m0, 35840
    s_mov_b32 s37, 24576
    buffer_load_dwordx4 v35, s[60:63], s37 offen nt lds
    s_mov_b32 m0, 69632
    s_mov_b32 s37, 128
    buffer_load_dwordx4 v34, s[60:63], s37 offen nt lds
    s_mov_b32 m0, 70656
    s_mov_b32 s37, 8320
    buffer_load_dwordx4 v35, s[60:63], s37 offen nt lds
    s_mov_b32 m0, 71680
    s_mov_b32 s37, 16512
    buffer_load_dwordx4 v34, s[60:63], s37 offen nt lds
    s_mov_b32 m0, 72704
    s_mov_b32 s37, 24704
    buffer_load_dwordx4 v35, s[60:63], s37 offen nt lds
    s_mov_b32 m0, 106496
    s_mov_b32 s37, 256
    buffer_load_dwordx4 v34, s[60:63], s37 offen nt lds
    s_mov_b32 m0, 107520
    s_mov_b32 s37, 8448
    buffer_load_dwordx4 v35, s[60:63], s37 offen nt lds
    s_mov_b32 m0, 108544
    s_mov_b32 s37, 16640
    buffer_load_dwordx4 v34, s[60:63], s37 offen nt lds
    s_mov_b32 m0, 109568
    s_mov_b32 s37, 24832
    buffer_load_dwordx4 v35, s[60:63], s37 offen nt lds
    s_mov_b32 m0, 143360
    s_mov_b32 s37, 384
    buffer_load_dwordx4 v34, s[60:63], s37 offen nt lds
    s_mov_b32 m0, 144384
    s_mov_b32 s37, 8576
    buffer_load_dwordx4 v35, s[60:63], s37 offen nt lds
    s_mov_b32 m0, 145408
    s_mov_b32 s37, 16768
    buffer_load_dwordx4 v34, s[60:63], s37 offen nt lds
    s_mov_b32 m0, 146432
    s_mov_b32 s37, 24960
    buffer_load_dwordx4 v35, s[60:63], s37 offen nt lds
    s_mov_b32 m0, 147456
    s_nop 0
    buffer_load_dwordx4 v36, s[64:67], 0 offen nt lds
    s_mov_b32 m0, 148480
    s_mov_b32 s37, 8192
    buffer_load_dwordx4 v36, s[64:67], s37 offen nt lds
    s_mov_b32 m0, 149504
    s_mov_b32 s37, 128
    buffer_load_dwordx4 v36, s[64:67], s37 offen nt lds
    s_mov_b32 m0, 150528
    s_mov_b32 s37, 8320
    buffer_load_dwordx4 v36, s[64:67], s37 offen nt lds
    s_mov_b32 m0, 151552
    s_mov_b32 s37, 256
    buffer_load_dwordx4 v36, s[64:67], s37 offen nt lds
    s_mov_b32 m0, 152576
    s_mov_b32 s37, 8448
    buffer_load_dwordx4 v36, s[64:67], s37 offen nt lds
    s_mov_b32 m0, 153600
    s_mov_b32 s37, 384
    buffer_load_dwordx4 v36, s[64:67], s37 offen nt lds
    s_mov_b32 m0, 154624
    s_mov_b32 s37, 8576
    buffer_load_dwordx4 v36, s[64:67], s37 offen nt lds
    s_waitcnt vmcnt(24)
    v_mov_b32 v16, 1
    ds_write_b32 v8, v16 offset:44
    s_waitcnt lgkmcnt(0)
    s_barrier
    s_waitcnt vmcnt(0)
    v_mov_b32 v16, 1
    ds_write_b32 v8, v16 offset:28
    s_endpgm
L_helper:
    s_mov_b32 s51, s2
    s_sub_u32 s42, s51, 128
    s_cmp_ge_u32 s42, 56
    s_cselect_b32 s40, 1, 0
    s_mul_i32 s43, s40, 56
    s_sub_u32 s42, s42, s43
    s_cmp_ge_u32 s42, 28
    s_cselect_b32 s39, 1, 0
    s_mul_i32 s43, s39, 28
    s_sub_u32 s38, s42, s43
    s_and_b32 s42, s51, 63
    s_lshr_b32 s43, s51, 6
    s_mov_b32 s41, 3584
    s_cmp_lt_u32 s51, 128
    s_cselect_b32 s38, s42, s38
    s_cselect_b32 s39, s43, s39
    s_cselect_b32 s41, 8192, s41
    s_cselect_b32 s40, 0, s40
    v_lshrrev_b32 v4, 3, v1
    v_and_b32 v5, 7, v1
    v_and_b32 v6, 2, v4
    v_xor_b32 v5, v5, v6
    v_lshlrev_b32 v5, 4, v5
    v_mul_lo_u32 v6, v4, s41
    v_add_u32 v76, v6, v5
    v_xor_b32 v77, 64, v76
    s_mul_i32 s44, s39, s41
    s_lshl_b32 s44, s44, 8
    s_lshl_b32 s45, s38, 7
    s_add_u32 s44, s44, s45
    v_and_b32 v4, 1, v2
    v_lshlrev_b32 v4, 10, v4
    v_lshl_add_u32 v4, v3, 4, v4
    s_lshl_b32 s42, s39, 9
    v_add_u32 v25, s42, v4
    v_lshlrev_b32 v24, 4, v1
    s_waitcnt lgkmcnt(0)
    s_load_dword s30, s[28:29], 0
    s_cmp_eq_u32 s40, 1
    s_cselect_b32 s42, s18, s16
    s_cselect_b32 s43, s19, s17
    s_cmp_lt_u32 s51, 128
    s_cselect_b32 s42, s10, s42
    s_cselect_b32 s43, s11, s43
    s_add_u32 s56, s42, s44
    s_addc_u32 s57, s43, 0
    s_mul_i32 s58, s41, 255
    s_add_u32 s58, s58, 128
    s_mov_b32 s59, 0x20000
    s_mov_b32 s60, s4
    s_mov_b32 s61, s5
    s_mov_b32 s62, 2048
    s_mov_b32 s63, 0x20000
    s_mov_b32 s72, s22
    s_mov_b32 s73, s23
    s_mov_b32 s74, 1024
    s_mov_b32 s75, 0x20000
    buffer_load_dwordx4 v[84:87], v25, s[60:63], 0 offen offset:0
    buffer_load_dwordx4 v[88:91], v25, s[60:63], 0 offen offset:64
    buffer_load_dwordx4 v[92:95], v25, s[60:63], 0 offen offset:128
    buffer_load_dwordx4 v[96:99], v25, s[60:63], 0 offen offset:192
    buffer_load_dwordx4 v[100:103], v25, s[60:63], 0 offen offset:256
    buffer_load_dwordx4 v[104:107], v25, s[60:63], 0 offen offset:320
    buffer_load_dwordx4 v[108:111], v25, s[60:63], 0 offen offset:384
    buffer_load_dwordx4 v[112:115], v25, s[60:63], 0 offen offset:448
    buffer_load_dwordx4 v[12:15], v24, s[60:63], 0 offen
    buffer_load_dwordx4 v[16:19], v24, s[60:63], 0 offen offset:1024
    buffer_load_dwordx4 v[20:23], v24, s[72:75], 0 offen
    s_cmp_ge_u32 s51, 240
    s_cbranch_scc1 L_noT1
    s_lshl_b32 s42, s41, 3
    s_mov_b32 s43, 0
    s_mov_b32 m0, 24576
    s_nop 0
    buffer_load_dwordx4 v76, s[56:59], s43 offen nt lds
    s_add_u32 s43, s43, s42
    s_mov_b32 m0, 25600
    s_nop 0
    buffer_load_dwordx4 v77, s[56:59], s43 offen nt lds
    s_add_u32 s43, s43, s42
    s_mov_b32 m0, 26624
    s_nop 0
    buffer_load_dwordx4 v76, s[56:59], s43 offen nt lds
    s_add_u32 s43, s43, s42
    s_mov_b32 m0, 27648
    s_nop 0
    buffer_load_dwordx4 v77, s[56:59], s43 offen nt lds
    s_add_u32 s43, s43, s42
    s_mov_b32 m0, 28672
    s_nop 0
    buffer_load_dwordx4 v76, s[56:59], s43 offen nt lds
    s_add_u32 s43, s43, s42
    s_mov_b32 m0, 29696
    s_nop 0
    buffer_load_dwordx4 v77, s[56:59], s43 offen nt lds
    s_add_u32 s43, s43, s42
    s_mov_b32 m0, 30720
    s_nop 0
    buffer_load_dwordx4 v76, s[56:59], s43 offen nt lds
    s_add_u32 s43, s43, s42
    s_mov_b32 m0, 31744
    s_nop 0
    buffer_load_dwordx4 v77, s[56:59], s43 offen nt lds
    s_add_u32 s43, s43, s42
    s_mov_b32 m0, 61440
    s_nop 0
    buffer_load_dwordx4 v76, s[56:59], s43 offen nt lds
    s_add_u32 s43, s43, s42
    s_mov_b32 m0, 62464
    s_nop 0
    buffer_load_dwordx4 v77, s[56:59], s43 offen nt lds
    s_add_u32 s43, s43, s42
    s_mov_b32 m0, 63488
    s_nop 0
    buffer_load_dwordx4 v76, s[56:59], s43 offen nt lds
    s_add_u32 s43, s43, s42
    s_mov_b32 m0, 64512
    s_nop 0
    buffer_load_dwordx4 v77, s[56:59], s43 offen nt lds
    s_add_u32 s43, s43, s42
    s_mov_b32 m0, 65536
    s_nop 0
    buffer_load_dwordx4 v76, s[56:59], s43 offen nt lds
    s_add_u32 s43, s43, s42
    s_mov_b32 m0, 66560
    s_nop 0
    buffer_load_dwordx4 v77, s[56:59], s43 offen nt lds
    s_add_u32 s43, s43, s42
    s_mov_b32 m0, 67584
    s_nop 0
    buffer_load_dwordx4 v76, s[56:59], s43 offen nt lds
    s_add_u32 s43, s43, s42
    s_mov_b32 m0, 68608
    s_nop 0
    buffer_load_dwordx4 v77, s[56:59], s43 offen nt lds
    s_add_u32 s43, s43, s42
    s_mov_b32 m0, 98304
    s_nop 0
    buffer_load_dwordx4 v76, s[56:59], s43 offen nt lds
    s_add_u32 s43, s43, s42
    s_mov_b32 m0, 99328
    s_nop 0
    buffer_load_dwordx4 v77, s[56:59], s43 offen nt lds
    s_add_u32 s43, s43, s42
    s_mov_b32 m0, 100352
    s_nop 0
    buffer_load_dwordx4 v76, s[56:59], s43 offen nt lds
    s_add_u32 s43, s43, s42
    s_mov_b32 m0, 101376
    s_nop 0
    buffer_load_dwordx4 v77, s[56:59], s43 offen nt lds
    s_add_u32 s43, s43, s42
    s_mov_b32 m0, 102400
    s_nop 0
    buffer_load_dwordx4 v76, s[56:59], s43 offen nt lds
    s_add_u32 s43, s43, s42
    s_mov_b32 m0, 103424
    s_nop 0
    buffer_load_dwordx4 v77, s[56:59], s43 offen nt lds
    s_add_u32 s43, s43, s42
    s_mov_b32 m0, 104448
    s_nop 0
    buffer_load_dwordx4 v76, s[56:59], s43 offen nt lds
    s_add_u32 s43, s43, s42
    s_mov_b32 m0, 105472
    s_nop 0
    buffer_load_dwordx4 v77, s[56:59], s43 offen nt lds
    s_add_u32 s43, s43, s42
    s_mov_b32 m0, 135168
    s_nop 0
    buffer_load_dwordx4 v76, s[56:59], s43 offen nt lds
    s_add_u32 s43, s43, s42
    s_mov_b32 m0, 136192
    s_nop 0
    buffer_load_dwordx4 v77, s[56:59], s43 offen nt lds
    s_add_u32 s43, s43, s42
    s_mov_b32 m0, 137216
    s_nop 0
    buffer_load_dwordx4 v76, s[56:59], s43 offen nt lds
    s_add_u32 s43, s43, s42
    s_mov_b32 m0, 138240
    s_nop 0
    buffer_load_dwordx4 v77, s[56:59], s43 offen nt lds
    s_add_u32 s43, s43, s42
    s_mov_b32 m0, 139264
    s_nop 0
    buffer_load_dwordx4 v76, s[56:59], s43 offen nt lds
    s_add_u32 s43, s43, s42
    s_mov_b32 m0, 140288
    s_nop 0
    buffer_load_dwordx4 v77, s[56:59], s43 offen nt lds
    s_add_u32 s43, s43, s42
    s_mov_b32 m0, 141312
    s_nop 0
    buffer_load_dwordx4 v76, s[56:59], s43 offen nt lds
    s_add_u32 s43, s43, s42
    s_mov_b32 m0, 142336
    s_nop 0
    buffer_load_dwordx4 v77, s[56:59], s43 offen nt lds
L_noT1:
    s_lshr_b32 s42, s35, 4
    s_lshl_b32 s43, s34, 1
    s_add_u32 s43, s43, s42
    s_lshl_b32 s43, s43, 4
    s_and_b32 s44, s35, 15
    s_add_u32 s47, s43, s44
    s_lshr_b32 s42, s35, 1
    s_lshl_b32 s48, s34, 4
    s_add_u32 s48, s48, s42
    s_and_b32 s49, s35, 1
    s_mul_i32 s50, s48, 14
    s_and_b32 s50, s50, -4
    s_mov_b32 s68, s28
    s_mov_b32 s69, s29
    s_mov_b32 s70, 1572864
    s_mov_b32 s71, 0x20000
    s_lshl_b32 s42, s47, 11
    s_add_u32 s42, s42, 131072
    v_add_u32 v25, s42, v24
    s_lshl_b32 s42, s48, 1
    s_add_u32 s42, s42, s49
    s_lshl_b32 s42, s42, 11
    s_add_u32 s42, s42, 786432
    v_add_u32 v26, s42, v24
    v_lshrrev_b32 v31, 3, v1
    v_and_b32 v31, 3, v31
    s_lshl_b32 s42, s34, 2
    v_add_u32 v31, s42, v31
    v_lshlrev_b32 v31, 5, v31
    v_add_u32 v31, s35, v31
    v_lshlrev_b32 v31, 7, v31
    v_and_b32 v32, 7, v1
    v_lshl_add_u32 v31, v32, 4, v31
    v_add_u32 v27, 655360, v31
    buffer_load_dwordx4 v[172:175], v26, s[68:71], 0 offen sc1
    buffer_load_dwordx4 v[176:179], v26, s[68:71], 0 offen offset:1024 sc1
    s_lshl_b32 s42, s39, 15
    s_add_u32 s42, s42, 8192
    s_lshl_b32 s43, s40, 1
    s_add_u32 s43, s43, s39
    s_mul_i32 s43, s43, 14336
    s_add_u32 s43, s43, 73728
    s_mov_b32 s45, 7168
    s_cmp_lt_u32 s51, 128
    s_cselect_b32 s42, s42, s43
    s_cselect_b32 s43, 16384, s45
    s_lshl_b32 s44, s38, 8
    s_add_u32 s42, s42, s44
    v_and_b32 v30, 1, v2
    v_mul_lo_u32 v25, v30, s43
    v_lshl_add_u32 v25, v3, 4, v25
    v_add_u32 v25, s42, v25
    v_lshrrev_b32 v4, 2, v1
    v_and_b32 v6, 3, v1
    v_and_b32 v5, 3, v4
    v_lshl_add_u32 v31, v3, 3, v5
    v_lshrrev_b32 v5, 1, v5
    v_and_b32 v32, 1, v3
    v_lshl_add_u32 v5, v32, 1, v5
    v_lshlrev_b32 v5, 5, v5
    v_lshl_add_u32 v5, v31, 7, v5
    v_lshl_add_u32 v5, v6, 3, v5
    v_add_u32 v78, 24576, v5
    v_xor_b32 v79, 32, v78
    v_xor_b32 v80, 64, v78
    v_xor_b32 v81, 96, v78
    s_waitcnt lgkmcnt(0)
    s_add_u32 s31, s30, 1
    s_not_b32 s32, s31
    s_and_b32 s42, s31, s33
    v_mov_b32 v7, s42
    s_barrier
    s_getreg_b32 s52, hwreg(HW_REG_XCC_ID, 0, 4)
    s_lshl_b32 s42, s52, 10
    v_or_b32 v72, s42, v7
    v_mov_b32 v73, v72
    v_mov_b32 v74, v72
    v_mov_b32 v75, v72
    s_lshl_b32 s42, s34, 5
    s_add_u32 s42, s42, s35
    s_lshl_b32 s42, s42, 4
    s_add_u32 s42, s42, 4096
    v_mov_b32 v31, s42
    s_mov_b32 exec_lo, 0x1
    s_mov_b32 exec_hi, 0x0
    buffer_store_dwordx4 v[72:75], v31, s[68:71], 0 offen sc1
    s_mov_b64 exec, -1
    s_cmp_ge_u32 s51, 240
    s_cbranch_scc1 L_noT2
    s_waitcnt vmcnt(2)
    ds_read_b64_tr_b16 v[116:117], v78 offset:0
    ds_read_b64_tr_b16 v[118:119], v78 offset:512
    ds_read_b64_tr_b16 v[120:121], v79 offset:0
    ds_read_b64_tr_b16 v[122:123], v79 offset:512
    ds_read_b64_tr_b16 v[124:125], v80 offset:0
    ds_read_b64_tr_b16 v[126:127], v80 offset:512
    ds_read_b64_tr_b16 v[128:129], v81 offset:0
    ds_read_b64_tr_b16 v[130:131], v81 offset:512
    ds_read_b64_tr_b16 v[132:133], v78 offset:4096
    ds_read_b64_tr_b16 v[134:135], v78 offset:4608
    ds_read_b64_tr_b16 v[136:137], v79 offset:4096
    ds_read_b64_tr_b16 v[138:139], v79 offset:4608
    ds_read_b64_tr_b16 v[140:141], v80 offset:4096
    ds_read_b64_tr_b16 v[142:143], v80 offset:4608
    s_waitcnt lgkmcnt(6)
    ds_read_b64_tr_b16 v[144:145], v81 offset:4096
    ds_read_b64_tr_b16 v[146:147], v81 offset:4608
    v_mfma_f32_16x16x32_bf16 v[148:151], v[116:119], v[84:87], 0
    v_mfma_f32_16x16x32_bf16 v[152:155], v[120:123], v[84:87], 0
    v_mfma_f32_16x16x32_bf16 v[156:159], v[124:127], v[84:87], 0
    v_mfma_f32_16x16x32_bf16 v[160:163], v[128:131], v[84:87], 0
    v_add_u32 v78, 36864, v78
    v_add_u32 v79, 36864, v79
    v_add_u32 v80, 36864, v80
    v_add_u32 v81, 36864, v81
    ds_read_b64_tr_b16 v[116:117], v78 offset:0
    ds_read_b64_tr_b16 v[118:119], v78 offset:512
    ds_read_b64_tr_b16 v[120:121], v79 offset:0
    ds_read_b64_tr_b16 v[122:123], v79 offset:512
    ds_read_b64_tr_b16 v[124:125], v80 offset:0
    ds_read_b64_tr_b16 v[126:127], v80 offset:512
    s_waitcnt lgkmcnt(6)
    ds_read_b64_tr_b16 v[128:129], v81 offset:0
    ds_read_b64_tr_b16 v[130:131], v81 offset:512
    v_mfma_f32_16x16x32_bf16 v[148:151], v[132:135], v[88:91], v[148:151]
    v_mfma_f32_16x16x32_bf16 v[152:155], v[136:139], v[88:91], v[152:155]
    v_mfma_f32_16x16x32_bf16 v[156:159], v[140:143], v[88:91], v[156:159]
    v_mfma_f32_16x16x32_bf16 v[160:163], v[144:147], v[88:91], v[160:163]
    ds_read_b64_tr_b16 v[132:133], v78 offset:4096
    ds_read_b64_tr_b16 v[134:135], v78 offset:4608
    ds_read_b64_tr_b16 v[136:137], v79 offset:4096
    ds_read_b64_tr_b16 v[138:139], v79 offset:4608
    ds_read_b64_tr_b16 v[140:141], v80 offset:4096
    ds_read_b64_tr_b16 v[142:143], v80 offset:4608
    s_waitcnt lgkmcnt(6)
    ds_read_b64_tr_b16 v[144:145], v81 offset:4096
    ds_read_b64_tr_b16 v[146:147], v81 offset:4608
    v_mfma_f32_16x16x32_bf16 v[148:151], v[116:119], v[92:95], v[148:151]
    v_mfma_f32_16x16x32_bf16 v[152:155], v[120:123], v[92:95], v[152:155]
    v_mfma_f32_16x16x32_bf16 v[156:159], v[124:127], v[92:95], v[156:159]
    v_mfma_f32_16x16x32_bf16 v[160:163], v[128:131], v[92:95], v[160:163]
    v_add_u32 v78, 36864, v78
    v_add_u32 v79, 36864, v79
    v_add_u32 v80, 36864, v80
    v_add_u32 v81, 36864, v81
    ds_read_b64_tr_b16 v[116:117], v78 offset:0
    ds_read_b64_tr_b16 v[118:119], v78 offset:512
    ds_read_b64_tr_b16 v[120:121], v79 offset:0
    ds_read_b64_tr_b16 v[122:123], v79 offset:512
    ds_read_b64_tr_b16 v[124:125], v80 offset:0
    ds_read_b64_tr_b16 v[126:127], v80 offset:512
    s_waitcnt lgkmcnt(6)
    ds_read_b64_tr_b16 v[128:129], v81 offset:0
    ds_read_b64_tr_b16 v[130:131], v81 offset:512
    v_mfma_f32_16x16x32_bf16 v[148:151], v[132:135], v[96:99], v[148:151]
    v_mfma_f32_16x16x32_bf16 v[152:155], v[136:139], v[96:99], v[152:155]
    v_mfma_f32_16x16x32_bf16 v[156:159], v[140:143], v[96:99], v[156:159]
    v_mfma_f32_16x16x32_bf16 v[160:163], v[144:147], v[96:99], v[160:163]
    ds_read_b64_tr_b16 v[132:133], v78 offset:4096
    ds_read_b64_tr_b16 v[134:135], v78 offset:4608
    ds_read_b64_tr_b16 v[136:137], v79 offset:4096
    ds_read_b64_tr_b16 v[138:139], v79 offset:4608
    ds_read_b64_tr_b16 v[140:141], v80 offset:4096
    ds_read_b64_tr_b16 v[142:143], v80 offset:4608
    s_waitcnt lgkmcnt(6)
    ds_read_b64_tr_b16 v[144:145], v81 offset:4096
    ds_read_b64_tr_b16 v[146:147], v81 offset:4608
    v_mfma_f32_16x16x32_bf16 v[148:151], v[116:119], v[100:103], v[148:151]
    v_mfma_f32_16x16x32_bf16 v[152:155], v[120:123], v[100:103], v[152:155]
    v_mfma_f32_16x16x32_bf16 v[156:159], v[124:127], v[100:103], v[156:159]
    v_mfma_f32_16x16x32_bf16 v[160:163], v[128:131], v[100:103], v[160:163]
    v_add_u32 v78, 36864, v78
    v_add_u32 v79, 36864, v79
    v_add_u32 v80, 36864, v80
    v_add_u32 v81, 36864, v81
    ds_read_b64_tr_b16 v[116:117], v78 offset:0
    ds_read_b64_tr_b16 v[118:119], v78 offset:512
    ds_read_b64_tr_b16 v[120:121], v79 offset:0
    ds_read_b64_tr_b16 v[122:123], v79 offset:512
    ds_read_b64_tr_b16 v[124:125], v80 offset:0
    ds_read_b64_tr_b16 v[126:127], v80 offset:512
    s_waitcnt lgkmcnt(6)
    ds_read_b64_tr_b16 v[128:129], v81 offset:0
    ds_read_b64_tr_b16 v[130:131], v81 offset:512
    v_mfma_f32_16x16x32_bf16 v[148:151], v[132:135], v[104:107], v[148:151]
    v_mfma_f32_16x16x32_bf16 v[152:155], v[136:139], v[104:107], v[152:155]
    v_mfma_f32_16x16x32_bf16 v[156:159], v[140:143], v[104:107], v[156:159]
    v_mfma_f32_16x16x32_bf16 v[160:163], v[144:147], v[104:107], v[160:163]
    ds_read_b64_tr_b16 v[132:133], v78 offset:4096
    ds_read_b64_tr_b16 v[134:135], v78 offset:4608
    ds_read_b64_tr_b16 v[136:137], v79 offset:4096
    ds_read_b64_tr_b16 v[138:139], v79 offset:4608
    ds_read_b64_tr_b16 v[140:141], v80 offset:4096
    ds_read_b64_tr_b16 v[142:143], v80 offset:4608
    s_waitcnt lgkmcnt(6)
    ds_read_b64_tr_b16 v[144:145], v81 offset:4096
    ds_read_b64_tr_b16 v[146:147], v81 offset:4608
    v_mfma_f32_16x16x32_bf16 v[148:151], v[116:119], v[108:111], v[148:151]
    v_mfma_f32_16x16x32_bf16 v[152:155], v[120:123], v[108:111], v[152:155]
    v_mfma_f32_16x16x32_bf16 v[156:159], v[124:127], v[108:111], v[156:159]
    v_mfma_f32_16x16x32_bf16 v[160:163], v[128:131], v[108:111], v[160:163]
    s_waitcnt lgkmcnt(0)
    v_mfma_f32_16x16x32_bf16 v[148:151], v[132:135], v[112:115], v[148:151]
    v_mfma_f32_16x16x32_bf16 v[152:155], v[136:139], v[112:115], v[152:155]
    v_mfma_f32_16x16x32_bf16 v[156:159], v[140:143], v[112:115], v[156:159]
    v_mfma_f32_16x16x32_bf16 v[160:163], v[144:147], v[112:115], v[160:163]
    s_nop 4
    v_bfi_b32 v148, s33, v7, v148
    v_bfi_b32 v149, s33, v7, v149
    v_bfi_b32 v150, s33, v7, v150
    v_bfi_b32 v151, s33, v7, v151
    v_bfi_b32 v152, s33, v7, v152
    v_bfi_b32 v153, s33, v7, v153
    v_bfi_b32 v154, s33, v7, v154
    v_bfi_b32 v155, s33, v7, v155
    v_bfi_b32 v156, s33, v7, v156
    v_bfi_b32 v157, s33, v7, v157
    v_bfi_b32 v158, s33, v7, v158
    v_bfi_b32 v159, s33, v7, v159
    v_bfi_b32 v160, s33, v7, v160
    v_bfi_b32 v161, s33, v7, v161
    v_bfi_b32 v162, s33, v7, v162
    v_bfi_b32 v163, s33, v7, v163
    s_mov_b32 exec_lo, 0x30003
    s_mov_b32 exec_hi, 0x30003
    buffer_store_dwordx4 v[148:151], v25, s[68:71], 0 offen offset:0 sc1
    buffer_store_dwordx4 v[152:155], v25, s[68:71], 0 offen offset:64 sc1
    buffer_store_dwordx4 v[156:159], v25, s[68:71], 0 offen offset:128 sc1
    buffer_store_dwordx4 v[160:163], v25, s[68:71], 0 offen offset:192 sc1
    s_mov_b64 exec, -1
L_noT2:
    v_mov_b32 v38, 1
    ds_write_b32 v8, v38 offset:16
    s_cmp_lt_u32 s51, 240
    s_cbranch_scc1 L_gw
    s_waitcnt vmcnt(0)
L_gw:
    v_mov_b32 v28, 0
    v_mov_b32 v29, 0
    v_lshlrev_b32 v38, 16, v12
    v_and_b32 v39, 0xffff0000, v12
    v_lshlrev_b32 v40, 16, v20
    v_and_b32 v41, 0xffff0000, v20
    v_mul_f32 v38, v38, v40
    v_mul_f32 v39, v39, v41
    v_cvt_pk_bf16_f32 v38, v38, v39
    v_and_b32 v39, 0xffff0000, v38
    v_lshlrev_b32 v38, 16, v38
    v_add_f32 v28, v28, v38
    v_add_f32 v28, v28, v39
    v_lshlrev_b32 v38, 16, v16
    v_and_b32 v39, 0xffff0000, v16
    v_lshlrev_b32 v40, 16, v20
    v_and_b32 v41, 0xffff0000, v20
    v_mul_f32 v38, v38, v40
    v_mul_f32 v39, v39, v41
    v_cvt_pk_bf16_f32 v38, v38, v39
    v_and_b32 v39, 0xffff0000, v38
    v_lshlrev_b32 v38, 16, v38
    v_add_f32 v29, v29, v38
    v_add_f32 v29, v29, v39
    v_lshlrev_b32 v38, 16, v13
    v_and_b32 v39, 0xffff0000, v13
    v_lshlrev_b32 v40, 16, v21
    v_and_b32 v41, 0xffff0000, v21
    v_mul_f32 v38, v38, v40
    v_mul_f32 v39, v39, v41
    v_cvt_pk_bf16_f32 v38, v38, v39
    v_and_b32 v39, 0xffff0000, v38
    v_lshlrev_b32 v38, 16, v38
    v_add_f32 v28, v28, v38
    v_add_f32 v28, v28, v39
    v_lshlrev_b32 v38, 16, v17
    v_and_b32 v39, 0xffff0000, v17
    v_lshlrev_b32 v40, 16, v21
    v_and_b32 v41, 0xffff0000, v21
    v_mul_f32 v38, v38, v40
    v_mul_f32 v39, v39, v41
    v_cvt_pk_bf16_f32 v38, v38, v39
    v_and_b32 v39, 0xffff0000, v38
    v_lshlrev_b32 v38, 16, v38
    v_add_f32 v29, v29, v38
    v_add_f32 v29, v29, v39
    v_lshlrev_b32 v38, 16, v14
    v_and_b32 v39, 0xffff0000, v14
    v_lshlrev_b32 v40, 16, v22
    v_and_b32 v41, 0xffff0000, v22
    v_mul_f32 v38, v38, v40
    v_mul_f32 v39, v39, v41
    v_cvt_pk_bf16_f32 v38, v38, v39
    v_and_b32 v39, 0xffff0000, v38
    v_lshlrev_b32 v38, 16, v38
    v_add_f32 v28, v28, v38
    v_add_f32 v28, v28, v39
    v_lshlrev_b32 v38, 16, v18
    v_and_b32 v39, 0xffff0000, v18
    v_lshlrev_b32 v40, 16, v22
    v_and_b32 v41, 0xffff0000, v22
    v_mul_f32 v38, v38, v40
    v_mul_f32 v39, v39, v41
    v_cvt_pk_bf16_f32 v38, v38, v39
    v_and_b32 v39, 0xffff0000, v38
    v_lshlrev_b32 v38, 16, v38
    v_add_f32 v29, v29, v38
    v_add_f32 v29, v29, v39
    v_lshlrev_b32 v38, 16, v15
    v_and_b32 v39, 0xffff0000, v15
    v_lshlrev_b32 v40, 16, v23
    v_and_b32 v41, 0xffff0000, v23
    v_mul_f32 v38, v38, v40
    v_mul_f32 v39, v39, v41
    v_cvt_pk_bf16_f32 v38, v38, v39
    v_and_b32 v39, 0xffff0000, v38
    v_lshlrev_b32 v38, 16, v38
    v_add_f32 v28, v28, v38
    v_add_f32 v28, v28, v39
    v_lshlrev_b32 v38, 16, v19
    v_and_b32 v39, 0xffff0000, v19
    v_lshlrev_b32 v40, 16, v23
    v_and_b32 v41, 0xffff0000, v23
    v_mul_f32 v38, v38, v40
    v_mul_f32 v39, v39, v41
    v_cvt_pk_bf16_f32 v38, v38, v39
    v_and_b32 v39, 0xffff0000, v38
    v_lshlrev_b32 v38, 16, v38
    v_add_f32 v29, v29, v38
    v_add_f32 v29, v29, v39
    v_add_f32_dpp v28, v28, v28 row_ror:1 row_mask:0xf bank_mask:0xf
    s_nop 0
    v_add_f32_dpp v29, v29, v29 row_ror:1 row_mask:0xf bank_mask:0xf
    v_add_f32_dpp v28, v28, v28 row_ror:2 row_mask:0xf bank_mask:0xf
    s_nop 0
    v_add_f32_dpp v29, v29, v29 row_ror:2 row_mask:0xf bank_mask:0xf
    v_add_f32_dpp v28, v28, v28 row_ror:4 row_mask:0xf bank_mask:0xf
    s_nop 0
    v_add_f32_dpp v29, v29, v29 row_ror:4 row_mask:0xf bank_mask:0xf
    v_add_f32_dpp v28, v28, v28 row_ror:8 row_mask:0xf bank_mask:0xf
    s_nop 0
    v_add_f32_dpp v29, v29, v29 row_ror:8 row_mask:0xf bank_mask:0xf
    v_mov_b32 v38, v28
    v_mov_b32 v39, v29
    s_nop 0
    v_permlane16_swap_b32 v28, v38
    v_permlane16_swap_b32 v29, v39
    v_add_f32 v28, v28, v38
    v_add_f32 v29, v29, v39
    v_mov_b32 v38, v28
    v_mov_b32 v39, v29
    s_nop 0
    v_permlane32_swap_b32 v28, v38
    v_permlane32_swap_b32 v29, v39
    v_add_f32 v28, v28, v38
    v_add_f32 v29, v29, v39
    v_cvt_pk_bf16_f32 v38, v28, v29
    v_lshlrev_b32 v28, 16, v38
    v_and_b32 v29, 0xffff0000, v38
    s_mov_b32 s42, 0xbfb8aa3b
    v_mul_f32 v28, s42, v28
    v_mul_f32 v29, s42, v29
    v_exp_f32 v28, v28
    v_exp_f32 v29, v29
    v_add_f32 v28, 1.0, v28
    v_add_f32 v29, 1.0, v29
    v_rcp_f32 v28, v28
    v_rcp_f32 v29, v29
    s_nop 0
    v_cvt_pk_bf16_f32 v38, v28, v29
    v_lshlrev_b32 v28, 16, v38
    v_and_b32 v29, 0xffff0000, v38
    v_mov_b32 v40, 157184
    ds_write_b32 v40, v28
    ds_write_b32 v40, v29 offset:4
    v_sub_f32 v28, 1.0, v28
    v_sub_f32 v29, 1.0, v29
    v_cvt_pk_bf16_f32 v38, v28, v29
    v_lshlrev_b32 v28, 16, v38
    v_and_b32 v29, 0xffff0000, v38
    s_lshr_b32 s42, s35, 4
    s_lshl_b32 s42, s42, 14
    s_lshl_b32 s43, s34, 11
    s_add_u32 s42, s42, s43
    s_add_u32 s42, s42, 8192
    v_add_u32 v26, s42, v24
    s_mov_b32 s46, 131072
    s_mov_b32 s45, 32768
    v_not_b32 v27, s33
    v_and_b32 v30, 3, v1
    v_bfe_u32 v31, v1, 2, 1
    v_bfe_u32 v32, v1, 3, 1
    v_lshlrev_b32 v25, 4, v30
    v_mul_u32_u24 v33, 7168, v31
    v_mul_u32_u24 v34, 14336, v32
    v_add3_u32 v25, v25, v33, v34
    s_lshl_b32 s42, s50, 2
    s_add_u32 s42, s42, 73728
    v_add_u32 v25, s42, v25
    s_mov_b32 s44, 28672
    v_and_b32 v35, 31, v1
    v_lshlrev_b32 v35, 4, v35
    s_lshl_b32 s42, s34, 9
    s_add_u32 s42, s42, 4096
    v_add_u32 v35, s42, v35
L_hq:
    s_sleep 16
    buffer_load_dwordx4 v[48:51], v26, s[68:71], 0 offen sc1
    buffer_load_dwordx4 v[52:55], v26, s[68:71], 0 offen offset:1024 sc1
    buffer_load_dwordx4 v[56:59], v26, s[68:71], s45 offen sc1
    buffer_load_dwordx4 v[60:63], v26, s[68:71], s45 offen offset:1024 sc1
    s_waitcnt vmcnt(0)
    v_bitop3_b32 v38, v48, v49, v7 bitop3:0x7e
    v_bitop3_b32 v39, v50, v51, v7 bitop3:0x7e
    v_bitop3_b32 v40, v52, v53, v7 bitop3:0x7e
    v_bitop3_b32 v41, v54, v55, v7 bitop3:0x7e
    v_bitop3_b32 v42, v56, v57, v7 bitop3:0x7e
    v_bitop3_b32 v43, v58, v59, v7 bitop3:0x7e
    v_bitop3_b32 v44, v60, v61, v7 bitop3:0x7e
    v_bitop3_b32 v45, v62, v63, v7 bitop3:0x7e
    v_or3_b32 v38, v38, v39, v40
    v_or3_b32 v41, v41, v42, v43
    v_or3_b32 v38, v38, v44, v45
    v_or_b32 v38, v38, v41
    v_and_b32 v38, s33, v38
    v_cmp_ne_u32 vcc, 0, v38
    s_cbranch_vccz L_hq_done
    s_mov_b64 exec, vcc
    s_sub_u32 s46, s46, 1
    s_cmp_lg_u32 s46, 0
    s_cbranch_scc1 L_hq
L_hq_done:
    s_mov_b64 exec, -1
    buffer_load_dwordx4 v[64:67], v25, s[68:71], 0 offen sc1
    buffer_load_dwordx4 v[68:71], v25, s[68:71], s44 offen sc1
    buffer_load_dwordx4 v[72:75], v35, s[68:71], 0 offen sc1
    v_and_b32 v48, v48, v27
    v_and_b32 v49, v49, v27
    v_and_b32 v50, v50, v27
    v_and_b32 v51, v51, v27
    v_and_b32 v52, v52, v27
    v_and_b32 v53, v53, v27
    v_and_b32 v54, v54, v27
    v_and_b32 v55, v55, v27
    v_and_b32 v56, v56, v27
    v_and_b32 v57, v57, v27
    v_and_b32 v58, v58, v27
    v_and_b32 v59, v59, v27
    v_and_b32 v60, v60, v27
    v_and_b32 v61, v61, v27
    v_and_b32 v62, v62, v27
    v_and_b32 v63, v63, v27
    v_add_f32 v48, v48, v56
    v_add_f32 v49, v49, v57
    v_add_f32 v50, v50, v58
    v_add_f32 v51, v51, v59
    v_add_f32 v52, v52, v60
    v_add_f32 v53, v53, v61
    v_add_f32 v54, v54, v62
    v_add_f32 v55, v55, v63
    v_cvt_pk_bf16_f32 v48, v48, v49
    v_cvt_pk_bf16_f32 v49, v50, v51
    v_cvt_pk_bf16_f32 v50, v52, v53
    v_cvt_pk_bf16_f32 v51, v54, v55
    v_lshlrev_b32 v24, 3, v1
    v_add_u32 v24, 155648, v24
    ds_write_b64 v24, v[48:49]
    ds_write_b64 v24, v[50:51] offset:512
    v_mov_b32 v38, 1
    ds_write_b32 v8, v38 offset:20
    s_mov_b32 s46, 131072
L_hf:
    s_waitcnt vmcnt(0)
    v_bitop3_b32 v38, v64, v65, v7 bitop3:0x7e
    v_bitop3_b32 v39, v66, v67, v7 bitop3:0x7e
    v_bitop3_b32 v40, v68, v69, v7 bitop3:0x7e
    v_bitop3_b32 v41, v70, v71, v7 bitop3:0x7e
    v_bitop3_b32 v42, v72, v73, v7 bitop3:0x7e
    v_bitop3_b32 v43, v74, v75, v7 bitop3:0x7e
    v_or3_b32 v41, v41, v42, v43
    v_or3_b32 v38, v38, v39, v40
    v_or_b32 v38, v38, v41
    v_and_b32 v38, s33, v38
    v_cmp_ne_u32 vcc, 0, v38
    s_cbranch_vccz L_hf_done
    s_mov_b64 exec, vcc
    s_sub_u32 s46, s46, 1
    s_cmp_lg_u32 s46, 0
    s_cbranch_scc0 L_hf_done
    s_sleep 16
    buffer_load_dwordx4 v[64:67], v25, s[68:71], 0 offen sc1
    buffer_load_dwordx4 v[68:71], v25, s[68:71], s44 offen sc1
    buffer_load_dwordx4 v[72:75], v35, s[68:71], 0 offen sc1
    s_branch L_hf
L_hf_done:
    s_mov_b64 exec, -1
    v_lshrrev_b32 v38, 10, v72
    v_cmp_ne_u32 vcc, s52, v38
    s_nop 0
    s_cmp_eq_u64 vcc, 0
    s_cselect_b32 s42, 1, 0
    v_mov_b32 v39, s42
    v_mov_b32 v40, 157184
    ds_write_b32 v40, v39 offset:8
    v_mov_b32 v45, v39
    v_and_b32 v64, v64, v27
    v_and_b32 v65, v65, v27
    v_and_b32 v66, v66, v27
    v_and_b32 v67, v67, v27
    v_and_b32 v68, v68, v27
    v_and_b32 v69, v69, v27
    v_and_b32 v70, v70, v27
    v_and_b32 v71, v71, v27
    v_add_f32_dpp v64, v64, v64 row_ror:8 row_mask:0xf bank_mask:0xf
    v_add_f32_dpp v65, v65, v65 row_ror:8 row_mask:0xf bank_mask:0xf
    v_add_f32_dpp v66, v66, v66 row_ror:8 row_mask:0xf bank_mask:0xf
    v_add_f32_dpp v67, v67, v67 row_ror:8 row_mask:0xf bank_mask:0xf
    v_add_f32_dpp v68, v68, v68 row_ror:8 row_mask:0xf bank_mask:0xf
    v_add_f32_dpp v69, v69, v69 row_ror:8 row_mask:0xf bank_mask:0xf
    v_add_f32_dpp v70, v70, v70 row_ror:8 row_mask:0xf bank_mask:0xf
    v_add_f32_dpp v71, v71, v71 row_ror:8 row_mask:0xf bank_mask:0xf
    v_cmp_eq_u32 vcc, 1, v31
    s_nop 1
    v_cndmask_b32 v28, v28, v29, vcc
    s_mov_b32 s42, 0xbfb8aa3b
    v_mul_f32 v48, s42, v64
    v_mul_f32 v49, s42, v65
    v_mul_f32 v50, s42, v66
    v_mul_f32 v51, s42, v67
    v_exp_f32 v48, v48
    v_exp_f32 v49, v49
    v_exp_f32 v50, v50
    v_exp_f32 v51, v51
    v_add_f32 v48, 1.0, v48
    v_add_f32 v49, 1.0, v49
    v_add_f32 v50, 1.0, v50
    v_add_f32 v51, 1.0, v51
    v_rcp_f32 v48, v48
    v_rcp_f32 v49, v49
    v_rcp_f32 v50, v50
    v_rcp_f32 v51, v51
    v_mul_f32 v64, v64, v48
    v_mul_f32 v65, v65, v49
    v_mul_f32 v66, v66, v50
    v_mul_f32 v67, v67, v51
    v_mul_f32 v64, v64, v68
    v_mul_f32 v65, v65, v69
    v_mul_f32 v66, v66, v70
    v_mul_f32 v67, v67, v71
    v_mul_f32 v64, v64, v28
    v_mul_f32 v65, v65, v28
    v_mul_f32 v66, v66, v28
    v_mul_f32 v67, v67, v28
    s_and_b32 s42, s48, 1
    s_cmp_eq_u32 s42, 0
    s_cselect_b32 s43, 3, 4
    s_cselect_b32 s44, 4, 0
    v_cmp_eq_u32 vcc, s43, v30
    s_nop 1
    v_cndmask_b32 v66, v66, 0, vcc
    v_cndmask_b32 v67, v67, 0, vcc
    v_cmp_eq_u32 vcc, s44, v30
    s_nop 1
    v_cndmask_b32 v64, v64, 0, vcc
    v_cndmask_b32 v65, v65, 0, vcc
    v_cvt_pk_bf16_f32 v64, v64, v65
    v_cvt_pk_bf16_f32 v65, v66, v67
    v_lshlrev_b32 v24, 5, v31
    v_lshl_add_u32 v24, v30, 3, v24
    v_add_u32 v24, 156928, v24
    ds_write_b64 v24, v[64:65]
    v_mov_b32 v38, 1
    ds_write_b32 v8, v38 offset:24
    s_waitcnt lgkmcnt(0)
L_end:
    s_endpgm

.section .rodata,"a"
.p2align 6
.amdhsa_kernel gated_mix__gqa_block_cached__swiglu_ffn__decode_kernel
  .amdhsa_next_free_vgpr 248
  .amdhsa_next_free_sgpr 96
  .amdhsa_accum_offset 248
  .amdhsa_group_segment_fixed_size 0
  .amdhsa_kernarg_size 104
  .amdhsa_user_sgpr_count 2
  .amdhsa_user_sgpr_kernarg_segment_ptr 1
  .amdhsa_system_sgpr_workgroup_id_x 1
  .amdhsa_float_denorm_mode_32 3
.end_amdhsa_kernel
```
